```python
import torch

def _softmax(x, axis=-1):
    return torch.softmax(x, dim=axis)

def _gelu(x):
    return torch.nn.functional.gelu(x, approximate='tanh')

def _silu(x):
    return torch.nn.functional.silu(x)

def _sigmoid(x):
    return torch.sigmoid(x)

def _layernorm(x, axis=-1, eps=1e-05):
    m = x.mean(dim=axis, keepdim=True)
    v = x.var(dim=axis, keepdim=True, unbiased=False)
    return (x - m) / torch.sqrt(v + eps)

def _scatter_add(tgt, idx, src, axis=0):
    return tgt.clone().index_add_(axis, idx, src)

def _segment_sum(src, seg, n):
    out = torch.zeros((n,) + src.shape[1:], dtype=src.dtype)
    return out.index_add_(0, seg, src)

def _pad(x, pw):
    flat = tuple((v for pair in reversed(pw) for v in pair))
    return torch.nn.functional.pad(x, flat)
kernel_name = 'standalone__tree_speculative_verify_tree_attention_over_candidate_token_tree__decode'

def setup_inputs():

    _w = lambda a: (lambda t: t.to(torch.bfloat16) if t.is_floating_point() else t)(torch.as_tensor(a))
    B, Hq, Hkv, T, C, D = (1, 16, 8, 1, 16384, 256)
    tree_mask = torch.zeros((B, T, T), dtype=float)
    for b in range(B):
        parent = torch.zeros(T, dtype=torch.int64)
        for i in range(1, T):
            parent[i] = int(torch.randint(0, i, (1,)).item())
        for i in range(T):
            j = i
            tree_mask[b, i, j] = 1.0
            while j > 0:
                j = parent[j]
                tree_mask[b, i, j] = 1.0
    return {'q': _w((lambda *s: torch.randn(*s, dtype=torch.bfloat16) * 0.8)(B, Hq, T, D)), 'k_cache': _w((lambda *s: torch.randn(*s, dtype=torch.bfloat16) * 0.8)(B, Hkv, C, D)), 'v_cache': _w((lambda *s: torch.randn(*s, dtype=torch.bfloat16) * 0.05)(B, Hkv, C, D)), 'k_tree': _w((lambda *s: torch.randn(*s, dtype=torch.bfloat16) * 0.8)(B, Hkv, T, D)), 'v_tree': _w((lambda *s: torch.randn(*s, dtype=torch.bfloat16) * 0.05)(B, Hkv, T, D)), 'tree_mask': _w(tree_mask)}

def reference(q, k_cache, v_cache, k_tree, v_tree, tree_mask):
    B, Hq, T, D = q.shape
    Hkv, C = (k_cache.shape[1], k_cache.shape[2])
    rep = Hq // Hkv
    kc = (lambda x, n, axis: torch.repeat_interleave(x, n, dim=axis))(k_cache, rep, axis=1)
    vc = (lambda x, n, axis: torch.repeat_interleave(x, n, dim=axis))(v_cache, rep, axis=1)
    kt = (lambda x, n, axis: torch.repeat_interleave(x, n, dim=axis))(k_tree, rep, axis=1)
    vt = (lambda x, n, axis: torch.repeat_interleave(x, n, dim=axis))(v_tree, rep, axis=1)
    k = torch.concatenate([kc, kt], axis=2)
    v = torch.concatenate([vc, vt], axis=2)
    scale = D ** (-0.5)
    scores = torch.einsum('bhqd,bhkd->bhqk', q, k) * scale
    ctx_mask = torch.ones((B, 1, T, C), dtype=scores.dtype)
    tm = tree_mask[:, None, :, :].clone()
    full_mask = torch.concatenate([ctx_mask, tm], axis=-1)
    scores = scores + (1.0 - full_mask) * -1000000000.0
    p = _softmax(scores, axis=-1)
    return torch.einsum('bhqk,bhkd->bhqd', p, v)
```

```asm
; @launch grid=(256,1,1) block=(256,1,1) lds=74752
.amdgcn_target "amdgcn-amd-amdhsa--gfx950"
.text
.globl standalone__tree_speculative_verify_tree_attention_over_candidate_token_tree__decode_kernel
.p2align 8
.type standalone__tree_speculative_verify_tree_attention_over_candidate_token_tree__decode_kernel,@function
standalone__tree_speculative_verify_tree_attention_over_candidate_token_tree__decode_kernel:
    s_cmp_ge_u32 s2, 256
    s_cbranch_scc1 L_end
    s_load_dwordx2 s[8:9], s[0:1], 8
    s_load_dwordx2 s[16:17], s[0:1], 64
    s_load_dwordx2 s[4:5], s[0:1], 0
    s_load_dwordx2 s[12:13], s[0:1], 16
    v_lshrrev_b32 v40, 6, v0
    v_and_b32 v1, 63, v0
    s_and_b32 s40, s2, 7
    v_readfirstlane_b32 s42, v40
    s_lshr_b32 s41, s2, 3
    v_lshrrev_b32 v40, 5, v1
    v_and_b32 v41, 31, v1
    v_lshlrev_b32 v42, 2, v40
    v_xor_b32 v41, v41, v42
    v_lshlrev_b32 v41, 4, v41
    v_lshl_add_u32 v41, v40, 9, v41
    s_lshl_b32 s45, s40, 23
    s_lshl_b32 s46, s41, 18
    s_add_u32 s45, s45, s46
    s_lshl_b32 s46, s42, 13
    s_add_u32 s45, s45, s46
    s_mul_i32 s53, s42, 16384
    v_add_u32 v41, s45, v41
    s_add_u32 s53, s53, 9216
    s_mov_b32 s10, 0x4000000
    s_mov_b32 s11, 0x20000
    s_mov_b32 s54, 0
    s_mov_b32 m0, s53
    v_mov_b32 v2, v41
    v_xor_b32 v3, 128, v41
    v_xor_b32 v4, 16, v41
    v_xor_b32 v5, 144, v41
    v_xor_b32 v6, 4128, v41
    v_xor_b32 v7, 4256, v41
    v_xor_b32 v8, 4144, v41
    v_xor_b32 v9, 4272, v41
    s_lshl_b32 s62, s40, 16
    s_lshl_b32 s46, s42, 14
    s_add_u32 s62, s62, s46
    s_lshl_b32 s63, s40, 10
    s_lshl_b32 s46, s42, 8
    s_add_u32 s63, s63, s46
    s_add_u32 s63, s63, 0x100000
    s_lshl_b32 s47, s41, 9
    s_add_u32 s47, s47, s62
    s_lshl_b32 s48, s41, 3
    s_add_u32 s48, s48, s63
    s_mov_b32 s18, 0x10000000
    s_mov_b32 s19, 0x20000
    v_mov_b32 v28, -1
    v_mov_b32 v29, -1
    v_mov_b32 v30, -1
    v_mov_b32 v31, -1
    v_lshlrev_b32 v45, 4, v1
    v_mov_b32 v44, 0
    s_waitcnt lgkmcnt(0)
    s_mov_b32 exec_hi, 0
    buffer_store_dwordx4 v[28:31], v45, s[16:19], s47 offen sc1
    s_mov_b64 exec, 1
    buffer_store_dwordx2 v[28:29], v44, s[16:19], s48 offen sc1
    s_mov_b64 exec, -1
    s_add_u32 s47, s47, 2097152
    s_add_u32 s48, s48, 2097152
    s_mov_b32 exec_hi, 0
    buffer_store_dwordx4 v[28:31], v45, s[16:19], s47 offen sc1
    s_mov_b64 exec, 1
    buffer_store_dwordx2 v[28:29], v44, s[16:19], s48 offen sc1
    s_mov_b64 exec, -1
    buffer_load_dwordx4 v2, s[8:11], s54 offen offset:0 nt lds
    buffer_load_dwordx4 v3, s[8:11], s54 offen offset:1024 nt lds
    buffer_load_dwordx4 v4, s[8:11], s54 offen offset:2048 nt lds
    buffer_load_dwordx4 v5, s[8:11], s54 offen offset:3072 nt lds
    s_add_u32 m0, s53, 4096
    s_nop 0
    buffer_load_dwordx4 v6, s[8:11], s54 offen offset:0 nt lds
    buffer_load_dwordx4 v7, s[8:11], s54 offen offset:1024 nt lds
    buffer_load_dwordx4 v8, s[8:11], s54 offen offset:2048 nt lds
    buffer_load_dwordx4 v9, s[8:11], s54 offen offset:3072 nt lds
    s_load_dwordx2 s[28:29], s[0:1], 24
    s_load_dwordx2 s[32:33], s[0:1], 32
    s_load_dwordx2 s[36:37], s[0:1], 40
    s_load_dwordx2 s[20:21], s[0:1], 48
    s_load_dwordx2 s[24:25], s[0:1], 56
    v_and_b32 v40, 15, v1
    v_lshrrev_b32 v42, 4, v1
    v_lshrrev_b32 v43, 3, v40
    s_lshl_b32 s46, s40, 10
    v_lshlrev_b32 v43, 9, v43
    v_lshl_add_u32 v43, v42, 4, v43
    s_mov_b32 s6, 8192
    s_mov_b32 s7, 0x20000
    v_add_u32 v43, s46, v43
    s_mov_b32 s14, 0x4000000
    s_mov_b32 s15, 0x20000
    buffer_load_dwordx4 v[64:67], v43, s[4:7], 0 offen offset:0
    buffer_load_dwordx4 v[68:71], v43, s[4:7], 0 offen offset:64
    buffer_load_dwordx4 v[72:75], v43, s[4:7], 0 offen offset:128
    buffer_load_dwordx4 v[76:79], v43, s[4:7], 0 offen offset:192
    buffer_load_dwordx4 v[80:83], v43, s[4:7], 0 offen offset:256
    buffer_load_dwordx4 v[84:87], v43, s[4:7], 0 offen offset:320
    buffer_load_dwordx4 v[88:91], v43, s[4:7], 0 offen offset:384
    buffer_load_dwordx4 v[92:95], v43, s[4:7], 0 offen offset:448
    s_or_b32 s44, s41, s42
    s_cmp_lg_u32 s44, 0
    s_cbranch_scc1 L_notree0
    s_mov_b32 s30, 4096
    s_mov_b32 s31, 0x20000
    s_mov_b32 s34, 4096
    s_mov_b32 s35, 0x20000
    s_mov_b32 s38, 2
    s_mov_b32 s39, 0x20000
    s_lshl_b32 s46, s40, 9
    v_lshlrev_b32 v44, 4, v42
    v_lshlrev_b32 v45, 4, v40
    v_mov_b32 v46, 0
    s_waitcnt lgkmcnt(0)
    buffer_load_dwordx4 v[96:99], v44, s[28:31], s46 offen offset:0
    buffer_load_dwordx4 v[100:103], v44, s[28:31], s46 offen offset:64
    buffer_load_dwordx4 v[104:107], v44, s[28:31], s46 offen offset:128
    buffer_load_dwordx4 v[108:111], v44, s[28:31], s46 offen offset:192
    buffer_load_dwordx4 v[112:115], v44, s[28:31], s46 offen offset:256
    buffer_load_dwordx4 v[116:119], v44, s[28:31], s46 offen offset:320
    buffer_load_dwordx4 v[120:123], v44, s[28:31], s46 offen offset:384
    buffer_load_dwordx4 v[124:127], v44, s[28:31], s46 offen offset:448
    buffer_load_dwordx4 v[56:59], v45, s[32:35], s46 offen offset:0
    buffer_load_dwordx4 v[60:63], v45, s[32:35], s46 offen offset:256
    buffer_load_ushort v47, v46, s[36:39], 0 offen
L_notree0:
    s_mov_b32 s55, 32768
    s_mov_b32 s56, 65536
    s_mov_b32 s57, 98304
    s_mov_b32 s58, 131072
    s_mov_b32 s59, 163840
    s_mov_b32 s60, 196608
    s_mov_b32 s61, 229376
    s_getreg_b32 s92, hwreg(HW_REG_XCC_ID)
    s_and_b32 s92, s92, 1
    s_cmp_lg_u32 s92, 1
    s_cbranch_scc1 L_noextra
    s_add_u32 m0, s53, 8192
    s_nop 0
    buffer_load_dwordx4 v2, s[8:11], s55 offen offset:0 nt lds
    buffer_load_dwordx4 v3, s[8:11], s55 offen offset:1024 nt lds
    buffer_load_dwordx4 v4, s[8:11], s55 offen offset:2048 nt lds
    buffer_load_dwordx4 v5, s[8:11], s55 offen offset:3072 nt lds
    s_add_u32 m0, s53, 12288
    s_nop 0
    buffer_load_dwordx4 v6, s[8:11], s55 offen offset:0 nt lds
    buffer_load_dwordx4 v7, s[8:11], s55 offen offset:1024 nt lds
    buffer_load_dwordx4 v8, s[8:11], s55 offen offset:2048 nt lds
    buffer_load_dwordx4 v9, s[8:11], s55 offen offset:3072 nt lds
L_noextra:
    v_lshlrev_b32 v14, 9, v42
    v_lshl_add_u32 v14, v40, 4, v14
    v_add_u32 v14, s45, v14
    v_add_u32 v15, 4096, v14
    s_mov_b32 s22, 8192
    s_mov_b32 s23, 0x20000
    s_mov_b32 s26, 256
    s_mov_b32 s27, 0x20000
    s_mov_b32 s43, 0x3db8aa3b
    v_and_b32 v50, 3, v40
    v_lshlrev_b32 v50, 2, v50
    v_lshrrev_b32 v51, 2, v40
    v_add_u32 v50, v50, v51
    v_lshlrev_b32 v50, 9, v50
    v_add_u32 v50, s53, v50
    v_xor_b32 v51, v42, v40
    v_lshlrev_b32 v51, 4, v51
    v_mov_b32 v10, v51
    v_xor_b32 v11, 64, v51
    v_xor_b32 v12, 128, v51
    v_xor_b32 v13, 192, v51
    v_add_u32 v10, v50, v10
    v_add_u32 v11, v50, v11
    v_add_u32 v12, v50, v12
    v_add_u32 v13, v50, v13
    v_and_b32 v51, 1, v1
    v_cmp_eq_u32 vcc, 1, v51
    v_mov_b32 v32, 0xffff
    v_mov_b32 v33, 0xffff0000
    v_bfe_u32 v51, v1, 1, 2
    v_cndmask_b32 v32, v32, v33, vcc
    v_cmp_eq_u32 vcc, 0, v51
    s_nop 1
    v_cndmask_b32 v16, 0, v32, vcc
    v_cmp_eq_u32 vcc, 1, v51
    s_nop 1
    v_cndmask_b32 v17, 0, v32, vcc
    v_cmp_eq_u32 vcc, 2, v51
    s_nop 1
    v_cndmask_b32 v18, 0, v32, vcc
    v_cmp_eq_u32 vcc, 3, v51
    s_nop 1
    v_cndmask_b32 v19, 0, v32, vcc
    v_mov_b32 v20, 0
    v_mov_b32 v24, 0
    v_mov_b32 v21, 0
    v_mov_b32 v25, 0
    v_mov_b32 v22, 0
    v_mov_b32 v26, 0
    v_mov_b32 v23, 0
    v_mov_b32 v27, 0
    v_mov_b32 v36, 0xff800000
    v_lshrrev_b32 v50, 3, v1
    v_and_b32 v51, 7, v1
    v_lshlrev_b32 v55, 5, v50
    v_lshlrev_b32 v160, 11, v50
    v_lshl_add_u32 v160, v51, 4, v160
    s_lshl_b32 s46, s42, 7
    v_add_u32 v160, s46, v160
    v_lshrrev_b32 v50, 4, v1
    v_lshlrev_b32 v50, 1, v50
    v_lshl_add_u32 v161, v51, 3, v50
    s_getreg_b32 s95, hwreg(HW_REG_XCC_ID)
    s_and_b32 s95, s95, 7
    s_mul_i32 s94, s95, s95
    s_lshl_b32 s94, s94, 14
    s_lshl_b32 s95, s95, 6
    s_add_u32 s94, s94, s95
    s_add_u32 s94, s94, 1
    s_lshl_b32 s95, s94, 5
    s_lshl_b32 s46, s40, 5
    s_cmp_eq_u32 s42, 0
    s_cselect_b32 s46, s46, 0x1000
    v_mov_b32 v54, s46
    s_waitcnt lgkmcnt(0)
    s_cmp_eq_u32 s92, 1
    s_cbranch_scc1 L_body1
    s_cmp_lg_u32 s44, 0
    s_cbranch_scc1 L_notree1a
    s_waitcnt vmcnt(0)
    v_mfma_f32_16x16x32_bf16 v[36:39], v[96:99], v[64:67], 0
    v_mfma_f32_16x16x32_bf16 v[36:39], v[100:103], v[68:71], v[36:39]
    v_mfma_f32_16x16x32_bf16 v[36:39], v[104:107], v[72:75], v[36:39]
    v_mfma_f32_16x16x32_bf16 v[36:39], v[108:111], v[76:79], v[36:39]
    v_mfma_f32_16x16x32_bf16 v[36:39], v[112:115], v[80:83], v[36:39]
    v_mfma_f32_16x16x32_bf16 v[36:39], v[116:119], v[84:87], v[36:39]
    v_mfma_f32_16x16x32_bf16 v[36:39], v[120:123], v[88:91], v[36:39]
    v_mfma_f32_16x16x32_bf16 v[36:39], v[124:127], v[92:95], v[36:39]
    v_lshlrev_b32 v47, 16, v47
    v_sub_f32 v47, 1.0, v47
    s_mov_b32 s46, 0xd06e6b28
    v_cmp_gt_u32 vcc, 16, v1
    v_mov_b32 v50, 0xff800000
    s_nop 4
    v_fma_f32 v36, v47, s46, v36
    v_cndmask_b32 v36, v50, v36, vcc
L_notree1a:
    s_waitcnt vmcnt(0)
    ds_read_b128 v[96:99], v10 offset:0
    ds_read_b128 v[100:103], v11 offset:0
    ds_read_b128 v[104:107], v12 offset:0
    ds_read_b128 v[108:111], v13 offset:0
    ds_read_b128 v[112:115], v10 offset:256
    ds_read_b128 v[116:119], v11 offset:256
    ds_read_b128 v[120:123], v12 offset:256
    ds_read_b128 v[124:127], v13 offset:256
    s_waitcnt lgkmcnt(7)
    v_mfma_f32_16x16x32_bf16 v[128:131], v[96:99], v[64:67], 0
    s_waitcnt lgkmcnt(6)
    v_mfma_f32_16x16x32_bf16 v[128:131], v[100:103], v[68:71], v[128:131]
    s_waitcnt lgkmcnt(5)
    v_mfma_f32_16x16x32_bf16 v[128:131], v[104:107], v[72:75], v[128:131]
    s_waitcnt lgkmcnt(4)
    v_mfma_f32_16x16x32_bf16 v[128:131], v[108:111], v[76:79], v[128:131]
    s_waitcnt lgkmcnt(3)
    v_mfma_f32_16x16x32_bf16 v[128:131], v[112:115], v[80:83], v[128:131]
    s_waitcnt lgkmcnt(2)
    v_mfma_f32_16x16x32_bf16 v[128:131], v[116:119], v[84:87], v[128:131]
    s_waitcnt lgkmcnt(1)
    v_mfma_f32_16x16x32_bf16 v[128:131], v[120:123], v[88:91], v[128:131]
    s_waitcnt lgkmcnt(0)
    v_mfma_f32_16x16x32_bf16 v[128:131], v[124:127], v[92:95], v[128:131]
    s_add_u32 m0, s53, 0
    s_nop 0
    buffer_load_dwordx4 v2, s[8:11], s55 offen offset:0 nt lds
    buffer_load_dwordx4 v3, s[8:11], s55 offen offset:1024 nt lds
    buffer_load_dwordx4 v4, s[8:11], s55 offen offset:2048 nt lds
    buffer_load_dwordx4 v5, s[8:11], s55 offen offset:3072 nt lds
    s_add_u32 m0, s53, 4096
    s_nop 0
    buffer_load_dwordx4 v6, s[8:11], s55 offen offset:0 nt lds
    buffer_load_dwordx4 v7, s[8:11], s55 offen offset:1024 nt lds
    buffer_load_dwordx4 v8, s[8:11], s55 offen offset:2048 nt lds
    buffer_load_dwordx4 v9, s[8:11], s55 offen offset:3072 nt lds
    s_waitcnt vmcnt(0)
    ds_read_b128 v[96:99], v10 offset:0
    ds_read_b128 v[100:103], v11 offset:0
    ds_read_b128 v[104:107], v12 offset:0
    ds_read_b128 v[108:111], v13 offset:0
    ds_read_b128 v[112:115], v10 offset:256
    ds_read_b128 v[116:119], v11 offset:256
    ds_read_b128 v[120:123], v12 offset:256
    ds_read_b128 v[124:127], v13 offset:256
    s_waitcnt lgkmcnt(7)
    v_mfma_f32_16x16x32_bf16 v[132:135], v[96:99], v[64:67], 0
    s_waitcnt lgkmcnt(6)
    v_mfma_f32_16x16x32_bf16 v[132:135], v[100:103], v[68:71], v[132:135]
    s_waitcnt lgkmcnt(5)
    v_mfma_f32_16x16x32_bf16 v[132:135], v[104:107], v[72:75], v[132:135]
    s_waitcnt lgkmcnt(4)
    v_mfma_f32_16x16x32_bf16 v[132:135], v[108:111], v[76:79], v[132:135]
    s_waitcnt lgkmcnt(3)
    v_mfma_f32_16x16x32_bf16 v[132:135], v[112:115], v[80:83], v[132:135]
    s_waitcnt lgkmcnt(2)
    v_mfma_f32_16x16x32_bf16 v[132:135], v[116:119], v[84:87], v[132:135]
    s_waitcnt lgkmcnt(1)
    v_mfma_f32_16x16x32_bf16 v[132:135], v[120:123], v[88:91], v[132:135]
    s_waitcnt lgkmcnt(0)
    v_mfma_f32_16x16x32_bf16 v[132:135], v[124:127], v[92:95], v[132:135]
    s_add_u32 m0, s53, 0
    s_nop 0
    buffer_load_dwordx4 v2, s[8:11], s56 offen offset:0 nt lds
    buffer_load_dwordx4 v3, s[8:11], s56 offen offset:1024 nt lds
    buffer_load_dwordx4 v4, s[8:11], s56 offen offset:2048 nt lds
    buffer_load_dwordx4 v5, s[8:11], s56 offen offset:3072 nt lds
    s_add_u32 m0, s53, 4096
    s_nop 0
    buffer_load_dwordx4 v6, s[8:11], s56 offen offset:0 nt lds
    buffer_load_dwordx4 v7, s[8:11], s56 offen offset:1024 nt lds
    buffer_load_dwordx4 v8, s[8:11], s56 offen offset:2048 nt lds
    buffer_load_dwordx4 v9, s[8:11], s56 offen offset:3072 nt lds
    s_waitcnt vmcnt(0)
    ds_read_b128 v[96:99], v10 offset:0
    ds_read_b128 v[100:103], v11 offset:0
    ds_read_b128 v[104:107], v12 offset:0
    ds_read_b128 v[108:111], v13 offset:0
    ds_read_b128 v[112:115], v10 offset:256
    ds_read_b128 v[116:119], v11 offset:256
    ds_read_b128 v[120:123], v12 offset:256
    ds_read_b128 v[124:127], v13 offset:256
    s_waitcnt lgkmcnt(7)
    v_mfma_f32_16x16x32_bf16 v[136:139], v[96:99], v[64:67], 0
    s_waitcnt lgkmcnt(6)
    v_mfma_f32_16x16x32_bf16 v[136:139], v[100:103], v[68:71], v[136:139]
    s_waitcnt lgkmcnt(5)
    v_mfma_f32_16x16x32_bf16 v[136:139], v[104:107], v[72:75], v[136:139]
    s_waitcnt lgkmcnt(4)
    v_mfma_f32_16x16x32_bf16 v[136:139], v[108:111], v[76:79], v[136:139]
    s_waitcnt lgkmcnt(3)
    v_mfma_f32_16x16x32_bf16 v[136:139], v[112:115], v[80:83], v[136:139]
    s_waitcnt lgkmcnt(2)
    v_mfma_f32_16x16x32_bf16 v[136:139], v[116:119], v[84:87], v[136:139]
    s_waitcnt lgkmcnt(1)
    v_mfma_f32_16x16x32_bf16 v[136:139], v[120:123], v[88:91], v[136:139]
    s_waitcnt lgkmcnt(0)
    v_mfma_f32_16x16x32_bf16 v[136:139], v[124:127], v[92:95], v[136:139]
    s_add_u32 m0, s53, 0
    s_nop 0
    buffer_load_dwordx4 v2, s[8:11], s57 offen offset:0 nt lds
    buffer_load_dwordx4 v3, s[8:11], s57 offen offset:1024 nt lds
    buffer_load_dwordx4 v4, s[8:11], s57 offen offset:2048 nt lds
    buffer_load_dwordx4 v5, s[8:11], s57 offen offset:3072 nt lds
    s_add_u32 m0, s53, 4096
    s_nop 0
    buffer_load_dwordx4 v6, s[8:11], s57 offen offset:0 nt lds
    buffer_load_dwordx4 v7, s[8:11], s57 offen offset:1024 nt lds
    buffer_load_dwordx4 v8, s[8:11], s57 offen offset:2048 nt lds
    buffer_load_dwordx4 v9, s[8:11], s57 offen offset:3072 nt lds
    s_waitcnt vmcnt(0)
    ds_read_b128 v[96:99], v10 offset:0
    ds_read_b128 v[100:103], v11 offset:0
    ds_read_b128 v[104:107], v12 offset:0
    ds_read_b128 v[108:111], v13 offset:0
    ds_read_b128 v[112:115], v10 offset:256
    ds_read_b128 v[116:119], v11 offset:256
    ds_read_b128 v[120:123], v12 offset:256
    ds_read_b128 v[124:127], v13 offset:256
    s_waitcnt lgkmcnt(7)
    v_mfma_f32_16x16x32_bf16 v[140:143], v[96:99], v[64:67], 0
    s_waitcnt lgkmcnt(6)
    v_mfma_f32_16x16x32_bf16 v[140:143], v[100:103], v[68:71], v[140:143]
    s_waitcnt lgkmcnt(5)
    v_mfma_f32_16x16x32_bf16 v[140:143], v[104:107], v[72:75], v[140:143]
    s_waitcnt lgkmcnt(4)
    v_mfma_f32_16x16x32_bf16 v[140:143], v[108:111], v[76:79], v[140:143]
    s_waitcnt lgkmcnt(3)
    v_mfma_f32_16x16x32_bf16 v[140:143], v[112:115], v[80:83], v[140:143]
    s_waitcnt lgkmcnt(2)
    v_mfma_f32_16x16x32_bf16 v[140:143], v[116:119], v[84:87], v[140:143]
    s_waitcnt lgkmcnt(1)
    v_mfma_f32_16x16x32_bf16 v[140:143], v[120:123], v[88:91], v[140:143]
    s_waitcnt lgkmcnt(0)
    v_mfma_f32_16x16x32_bf16 v[140:143], v[124:127], v[92:95], v[140:143]
    s_add_u32 m0, s53, 0
    s_nop 0
    buffer_load_dwordx4 v2, s[8:11], s58 offen offset:0 nt lds
    buffer_load_dwordx4 v3, s[8:11], s58 offen offset:1024 nt lds
    buffer_load_dwordx4 v4, s[8:11], s58 offen offset:2048 nt lds
    buffer_load_dwordx4 v5, s[8:11], s58 offen offset:3072 nt lds
    s_add_u32 m0, s53, 4096
    s_nop 0
    buffer_load_dwordx4 v6, s[8:11], s58 offen offset:0 nt lds
    buffer_load_dwordx4 v7, s[8:11], s58 offen offset:1024 nt lds
    buffer_load_dwordx4 v8, s[8:11], s58 offen offset:2048 nt lds
    buffer_load_dwordx4 v9, s[8:11], s58 offen offset:3072 nt lds
    s_waitcnt vmcnt(0)
    ds_read_b128 v[96:99], v10 offset:0
    ds_read_b128 v[100:103], v11 offset:0
    ds_read_b128 v[104:107], v12 offset:0
    ds_read_b128 v[108:111], v13 offset:0
    ds_read_b128 v[112:115], v10 offset:256
    ds_read_b128 v[116:119], v11 offset:256
    ds_read_b128 v[120:123], v12 offset:256
    ds_read_b128 v[124:127], v13 offset:256
    s_waitcnt lgkmcnt(7)
    v_mfma_f32_16x16x32_bf16 v[144:147], v[96:99], v[64:67], 0
    s_waitcnt lgkmcnt(6)
    v_mfma_f32_16x16x32_bf16 v[144:147], v[100:103], v[68:71], v[144:147]
    s_waitcnt lgkmcnt(5)
    v_mfma_f32_16x16x32_bf16 v[144:147], v[104:107], v[72:75], v[144:147]
    s_waitcnt lgkmcnt(4)
    v_mfma_f32_16x16x32_bf16 v[144:147], v[108:111], v[76:79], v[144:147]
    s_waitcnt lgkmcnt(3)
    v_mfma_f32_16x16x32_bf16 v[144:147], v[112:115], v[80:83], v[144:147]
    s_waitcnt lgkmcnt(2)
    v_mfma_f32_16x16x32_bf16 v[144:147], v[116:119], v[84:87], v[144:147]
    s_waitcnt lgkmcnt(1)
    v_mfma_f32_16x16x32_bf16 v[144:147], v[120:123], v[88:91], v[144:147]
    s_waitcnt lgkmcnt(0)
    v_mfma_f32_16x16x32_bf16 v[144:147], v[124:127], v[92:95], v[144:147]
    s_add_u32 m0, s53, 0
    s_nop 0
    buffer_load_dwordx4 v2, s[8:11], s59 offen offset:0 nt lds
    buffer_load_dwordx4 v3, s[8:11], s59 offen offset:1024 nt lds
    buffer_load_dwordx4 v4, s[8:11], s59 offen offset:2048 nt lds
    buffer_load_dwordx4 v5, s[8:11], s59 offen offset:3072 nt lds
    s_add_u32 m0, s53, 4096
    s_nop 0
    buffer_load_dwordx4 v6, s[8:11], s59 offen offset:0 nt lds
    buffer_load_dwordx4 v7, s[8:11], s59 offen offset:1024 nt lds
    buffer_load_dwordx4 v8, s[8:11], s59 offen offset:2048 nt lds
    buffer_load_dwordx4 v9, s[8:11], s59 offen offset:3072 nt lds
    s_waitcnt vmcnt(0)
    ds_read_b128 v[96:99], v10 offset:0
    ds_read_b128 v[100:103], v11 offset:0
    ds_read_b128 v[104:107], v12 offset:0
    ds_read_b128 v[108:111], v13 offset:0
    ds_read_b128 v[112:115], v10 offset:256
    ds_read_b128 v[116:119], v11 offset:256
    ds_read_b128 v[120:123], v12 offset:256
    ds_read_b128 v[124:127], v13 offset:256
    s_waitcnt lgkmcnt(7)
    v_mfma_f32_16x16x32_bf16 v[148:151], v[96:99], v[64:67], 0
    s_waitcnt lgkmcnt(6)
    v_mfma_f32_16x16x32_bf16 v[148:151], v[100:103], v[68:71], v[148:151]
    s_waitcnt lgkmcnt(5)
    v_mfma_f32_16x16x32_bf16 v[148:151], v[104:107], v[72:75], v[148:151]
    s_waitcnt lgkmcnt(4)
    v_mfma_f32_16x16x32_bf16 v[148:151], v[108:111], v[76:79], v[148:151]
    s_waitcnt lgkmcnt(3)
    v_mfma_f32_16x16x32_bf16 v[148:151], v[112:115], v[80:83], v[148:151]
    s_waitcnt lgkmcnt(2)
    v_mfma_f32_16x16x32_bf16 v[148:151], v[116:119], v[84:87], v[148:151]
    s_waitcnt lgkmcnt(1)
    v_mfma_f32_16x16x32_bf16 v[148:151], v[120:123], v[88:91], v[148:151]
    s_waitcnt lgkmcnt(0)
    v_mfma_f32_16x16x32_bf16 v[148:151], v[124:127], v[92:95], v[148:151]
    s_add_u32 m0, s53, 0
    s_nop 0
    buffer_load_dwordx4 v2, s[8:11], s60 offen offset:0 nt lds
    buffer_load_dwordx4 v3, s[8:11], s60 offen offset:1024 nt lds
    buffer_load_dwordx4 v4, s[8:11], s60 offen offset:2048 nt lds
    buffer_load_dwordx4 v5, s[8:11], s60 offen offset:3072 nt lds
    s_add_u32 m0, s53, 4096
    s_nop 0
    buffer_load_dwordx4 v6, s[8:11], s60 offen offset:0 nt lds
    buffer_load_dwordx4 v7, s[8:11], s60 offen offset:1024 nt lds
    buffer_load_dwordx4 v8, s[8:11], s60 offen offset:2048 nt lds
    buffer_load_dwordx4 v9, s[8:11], s60 offen offset:3072 nt lds
    s_waitcnt vmcnt(0)
    ds_read_b128 v[96:99], v10 offset:0
    ds_read_b128 v[100:103], v11 offset:0
    ds_read_b128 v[104:107], v12 offset:0
    ds_read_b128 v[108:111], v13 offset:0
    ds_read_b128 v[112:115], v10 offset:256
    ds_read_b128 v[116:119], v11 offset:256
    ds_read_b128 v[120:123], v12 offset:256
    ds_read_b128 v[124:127], v13 offset:256
    s_waitcnt lgkmcnt(7)
    v_mfma_f32_16x16x32_bf16 v[152:155], v[96:99], v[64:67], 0
    s_waitcnt lgkmcnt(6)
    v_mfma_f32_16x16x32_bf16 v[152:155], v[100:103], v[68:71], v[152:155]
    s_waitcnt lgkmcnt(5)
    v_mfma_f32_16x16x32_bf16 v[152:155], v[104:107], v[72:75], v[152:155]
    s_waitcnt lgkmcnt(4)
    v_mfma_f32_16x16x32_bf16 v[152:155], v[108:111], v[76:79], v[152:155]
    s_waitcnt lgkmcnt(3)
    v_mfma_f32_16x16x32_bf16 v[152:155], v[112:115], v[80:83], v[152:155]
    s_waitcnt lgkmcnt(2)
    v_mfma_f32_16x16x32_bf16 v[152:155], v[116:119], v[84:87], v[152:155]
    s_waitcnt lgkmcnt(1)
    v_mfma_f32_16x16x32_bf16 v[152:155], v[120:123], v[88:91], v[152:155]
    s_waitcnt lgkmcnt(0)
    v_mfma_f32_16x16x32_bf16 v[152:155], v[124:127], v[92:95], v[152:155]
    s_add_u32 m0, s53, 0
    s_nop 0
    buffer_load_dwordx4 v2, s[8:11], s61 offen offset:0 nt lds
    buffer_load_dwordx4 v3, s[8:11], s61 offen offset:1024 nt lds
    buffer_load_dwordx4 v4, s[8:11], s61 offen offset:2048 nt lds
    buffer_load_dwordx4 v5, s[8:11], s61 offen offset:3072 nt lds
    s_add_u32 m0, s53, 4096
    s_nop 0
    buffer_load_dwordx4 v6, s[8:11], s61 offen offset:0 nt lds
    buffer_load_dwordx4 v7, s[8:11], s61 offen offset:1024 nt lds
    buffer_load_dwordx4 v8, s[8:11], s61 offen offset:2048 nt lds
    buffer_load_dwordx4 v9, s[8:11], s61 offen offset:3072 nt lds
    s_waitcnt vmcnt(0)
    ds_read_b128 v[96:99], v10 offset:0
    ds_read_b128 v[100:103], v11 offset:0
    ds_read_b128 v[104:107], v12 offset:0
    ds_read_b128 v[108:111], v13 offset:0
    ds_read_b128 v[112:115], v10 offset:256
    ds_read_b128 v[116:119], v11 offset:256
    ds_read_b128 v[120:123], v12 offset:256
    ds_read_b128 v[124:127], v13 offset:256
    s_waitcnt lgkmcnt(7)
    v_mfma_f32_16x16x32_bf16 v[156:159], v[96:99], v[64:67], 0
    s_waitcnt lgkmcnt(6)
    v_mfma_f32_16x16x32_bf16 v[156:159], v[100:103], v[68:71], v[156:159]
    s_waitcnt lgkmcnt(5)
    v_mfma_f32_16x16x32_bf16 v[156:159], v[104:107], v[72:75], v[156:159]
    s_waitcnt lgkmcnt(4)
    v_mfma_f32_16x16x32_bf16 v[156:159], v[108:111], v[76:79], v[156:159]
    s_waitcnt lgkmcnt(3)
    v_mfma_f32_16x16x32_bf16 v[156:159], v[112:115], v[80:83], v[156:159]
    s_waitcnt lgkmcnt(2)
    v_mfma_f32_16x16x32_bf16 v[156:159], v[116:119], v[84:87], v[156:159]
    s_waitcnt lgkmcnt(1)
    v_mfma_f32_16x16x32_bf16 v[156:159], v[120:123], v[88:91], v[156:159]
    s_waitcnt lgkmcnt(0)
    v_mfma_f32_16x16x32_bf16 v[156:159], v[124:127], v[92:95], v[156:159]
    buffer_load_dwordx4 a[0:3], v14, s[12:15], s54 offen offset:0 nt
    buffer_load_dwordx4 a[4:7], v14, s[12:15], s54 offen offset:256 nt
    buffer_load_dwordx4 a[8:11], v14, s[12:15], s54 offen offset:2048 nt
    buffer_load_dwordx4 a[12:15], v14, s[12:15], s54 offen offset:2304 nt
    buffer_load_dwordx4 a[16:19], v15, s[12:15], s54 offen offset:0 nt
    buffer_load_dwordx4 a[20:23], v15, s[12:15], s54 offen offset:256 nt
    buffer_load_dwordx4 a[24:27], v15, s[12:15], s54 offen offset:2048 nt
    buffer_load_dwordx4 a[28:31], v15, s[12:15], s54 offen offset:2304 nt
    v_max3_f32 v50, v128, v129, v36
    v_max3_f32 v50, v130, v131, v50
    v_max3_f32 v50, v132, v133, v50
    v_max3_f32 v50, v134, v135, v50
    v_max3_f32 v50, v136, v137, v50
    v_max3_f32 v50, v138, v139, v50
    v_max3_f32 v50, v140, v141, v50
    v_max3_f32 v50, v142, v143, v50
    v_max3_f32 v50, v144, v145, v50
    v_max3_f32 v50, v146, v147, v50
    v_max3_f32 v50, v148, v149, v50
    v_max3_f32 v50, v150, v151, v50
    v_max3_f32 v50, v152, v153, v50
    v_max3_f32 v50, v154, v155, v50
    v_bfe_u32 v40, v1, 3, 1
    v_lshlrev_b32 v40, 4, v40
    s_lshl_b32 s45, s42, 2
    v_add_u32 v41, s45, v40
    s_nop 3
    v_max3_f32 v50, v156, v157, v50
    v_max3_f32 v50, v158, v159, v50
    v_mov_b32 v51, v50
    s_nop 1
    v_permlane16_swap_b32 v50, v51
    v_max_f32 v50, v50, v51
    v_mov_b32 v51, v50
    s_nop 1
    v_permlane32_swap_b32 v50, v51
    v_max_f32 v50, v50, v51
    s_mov_b64 exec, 0x101
    ds_write_b32 v41, v50 offset:8192
    s_mov_b64 exec, -1
    s_waitcnt lgkmcnt(0)
    s_barrier
    ds_read_b128 v[28:31], v40 offset:8192
    v_mov_b32 v52, s94
    s_mov_b64 exec, 1
    buffer_atomic_add v52, v54, s[24:27], 0 offen
    s_mov_b64 exec, -1
    s_waitcnt lgkmcnt(0)
    v_max3_f32 v50, v28, v29, v30
    v_max_f32 v50, v50, v31
    v_mul_f32 v48, s43, v50
    v_fma_f32 v36, v36, s43, -v48
    v_fma_f32 v128, v128, s43, -v48
    v_fma_f32 v129, v129, s43, -v48
    v_fma_f32 v130, v130, s43, -v48
    v_fma_f32 v131, v131, s43, -v48
    v_fma_f32 v132, v132, s43, -v48
    v_fma_f32 v133, v133, s43, -v48
    v_fma_f32 v134, v134, s43, -v48
    v_fma_f32 v135, v135, s43, -v48
    v_fma_f32 v136, v136, s43, -v48
    v_fma_f32 v137, v137, s43, -v48
    v_fma_f32 v138, v138, s43, -v48
    v_fma_f32 v139, v139, s43, -v48
    v_fma_f32 v140, v140, s43, -v48
    v_fma_f32 v141, v141, s43, -v48
    v_fma_f32 v142, v142, s43, -v48
    v_fma_f32 v143, v143, s43, -v48
    v_fma_f32 v144, v144, s43, -v48
    v_fma_f32 v145, v145, s43, -v48
    v_fma_f32 v146, v146, s43, -v48
    v_fma_f32 v147, v147, s43, -v48
    v_fma_f32 v148, v148, s43, -v48
    v_fma_f32 v149, v149, s43, -v48
    v_fma_f32 v150, v150, s43, -v48
    v_fma_f32 v151, v151, s43, -v48
    v_fma_f32 v152, v152, s43, -v48
    v_fma_f32 v153, v153, s43, -v48
    v_fma_f32 v154, v154, s43, -v48
    v_fma_f32 v155, v155, s43, -v48
    v_fma_f32 v156, v156, s43, -v48
    v_fma_f32 v157, v157, s43, -v48
    v_fma_f32 v158, v158, s43, -v48
    v_fma_f32 v159, v159, s43, -v48
    v_exp_f32 v36, v36
    v_exp_f32 v128, v128
    v_exp_f32 v129, v129
    v_exp_f32 v130, v130
    v_exp_f32 v131, v131
    v_exp_f32 v132, v132
    v_exp_f32 v133, v133
    v_exp_f32 v134, v134
    v_exp_f32 v135, v135
    v_exp_f32 v136, v136
    v_exp_f32 v137, v137
    v_exp_f32 v138, v138
    v_exp_f32 v139, v139
    v_exp_f32 v140, v140
    v_exp_f32 v141, v141
    v_exp_f32 v142, v142
    v_exp_f32 v143, v143
    v_exp_f32 v144, v144
    v_exp_f32 v145, v145
    v_exp_f32 v146, v146
    v_exp_f32 v147, v147
    v_exp_f32 v148, v148
    v_exp_f32 v149, v149
    v_exp_f32 v150, v150
    v_exp_f32 v151, v151
    v_exp_f32 v152, v152
    v_exp_f32 v153, v153
    v_exp_f32 v154, v154
    v_exp_f32 v155, v155
    v_exp_f32 v156, v156
    v_exp_f32 v157, v157
    v_exp_f32 v158, v158
    v_exp_f32 v159, v159
    v_add_f32 v49, v36, v128
    v_add_f32 v50, v129, v130
    v_add_f32 v49, v49, v131
    v_add_f32 v50, v50, v132
    v_add_f32 v49, v49, v133
    v_add_f32 v50, v50, v134
    v_add_f32 v49, v49, v135
    v_add_f32 v50, v50, v136
    v_add_f32 v49, v49, v137
    v_add_f32 v50, v50, v138
    v_add_f32 v49, v49, v139
    v_add_f32 v50, v50, v140
    v_add_f32 v49, v49, v141
    v_add_f32 v50, v50, v142
    v_add_f32 v49, v49, v143
    v_add_f32 v50, v50, v144
    v_add_f32 v49, v49, v145
    v_add_f32 v50, v50, v146
    v_add_f32 v49, v49, v147
    v_add_f32 v50, v50, v148
    v_add_f32 v49, v49, v149
    v_add_f32 v50, v50, v150
    v_add_f32 v49, v49, v151
    v_add_f32 v50, v50, v152
    v_add_f32 v49, v49, v153
    v_add_f32 v50, v50, v154
    v_add_f32 v49, v49, v155
    v_add_f32 v50, v50, v156
    v_add_f32 v49, v49, v157
    v_add_f32 v50, v50, v158
    v_add_f32 v49, v49, v159
    v_add_f32 v49, v49, v50
    v_mov_b32 v51, v49
    s_nop 1
    v_permlane16_swap_b32 v49, v51
    v_add_f32 v49, v49, v51
    v_mov_b32 v51, v49
    s_nop 1
    v_permlane32_swap_b32 v49, v51
    v_add_f32 v49, v49, v51
    s_mov_b64 exec, 0x101
    ds_write_b32 v41, v49 offset:8224
    s_mov_b64 exec, -1
    s_lshr_b32 s46, s42, 1
    s_lshl_b32 s47, s46, 3
    s_nop 0
    v_readlane_b32 s93, v48, s47
    v_lshrrev_b32 v41, 5, v1
    v_lshlrev_b32 v41, 7, v41
    v_bfe_u32 v44, v1, 4, 1
    v_lshl_add_u32 v41, v44, 6, v41
    v_bfe_u32 v44, v1, 2, 2
    v_lshl_add_u32 v41, v44, 4, v41
    v_and_b32 v44, 3, v1
    v_lshl_add_u32 v41, v44, 2, v41
    s_lshl_b32 s45, s42, 11
    v_add_u32 v41, s45, v41
    v_bfe_u32 v42, v1, 1, 2
    v_lshlrev_b32 v42, 8, v42
    v_bfe_u32 v44, v1, 3, 2
    v_lshl_add_u32 v42, v44, 6, v42
    v_and_b32 v44, 1, v1
    v_lshl_add_u32 v42, v44, 4, v42
    s_and_b32 s45, s42, 1
    s_lshl_b32 s45, s45, 10
    s_lshl_b32 s47, s46, 5
    s_add_u32 s45, s45, s47
    v_add_u32 v42, s45, v42
    s_lshl_b32 s47, s46, 4
    v_mov_b32 v43, s47
    v_mov_b32 v45, 0
    v_and_b32 v46, 31, v1
    v_lshlrev_b32 v47, 3, v46
    v_lshlrev_b32 v46, 4, v46
    v_lshrrev_b32 v44, 5, v1
    v_lshl_add_u32 v47, v44, 2, v47
    v_mov_b32 v48, s93
    s_lshl_b32 s45, s41, 9
    s_add_u32 s45, s45, s62
    s_lshl_b32 s46, s41, 3
    s_add_u32 s46, s46, s63
    s_lshl_b32 s47, s40, 10
    s_lshl_b32 s49, s42, 8
    s_add_u32 s47, s47, s49
    s_mov_b32 s50, 0
    s_cmp_lg_u32 s44, 0
    s_cbranch_scc1 L_notree2a
    v_cvt_pk_bf16_f32 v51, v36, v36
    v_and_b32 v28, v51, v16
    v_and_b32 v29, v51, v17
    v_and_b32 v30, v51, v18
    v_and_b32 v31, v51, v19
    s_nop 1
    v_mfma_f32_16x16x32_bf16 v[20:23], v[56:59], v[28:31], v[20:23]
    v_mfma_f32_16x16x32_bf16 v[24:27], v[60:63], v[28:31], v[24:27]
L_notree2a:
    v_cvt_pk_bf16_f32 v51, v128, v128
    v_and_b32 v32, v51, v16
    v_and_b32 v33, v51, v17
    v_and_b32 v34, v51, v18
    v_and_b32 v35, v51, v19
    s_nop 0
    s_waitcnt vmcnt(8)
    v_mfma_f32_16x16x32_bf16 v[20:23], a[0:3], v[32:35], v[20:23]
    s_waitcnt vmcnt(7)
    v_mfma_f32_16x16x32_bf16 v[24:27], a[4:7], v[32:35], v[24:27]
    v_cvt_pk_bf16_f32 v51, v129, v129
    v_and_b32 v28, v51, v16
    v_and_b32 v29, v51, v17
    v_and_b32 v30, v51, v18
    v_and_b32 v31, v51, v19
    s_nop 0
    s_waitcnt vmcnt(6)
    v_mfma_f32_16x16x32_bf16 v[20:23], a[8:11], v[28:31], v[20:23]
    s_waitcnt vmcnt(5)
    v_mfma_f32_16x16x32_bf16 v[24:27], a[12:15], v[28:31], v[24:27]
    v_cvt_pk_bf16_f32 v51, v130, v130
    v_and_b32 v32, v51, v16
    v_and_b32 v33, v51, v17
    v_and_b32 v34, v51, v18
    v_and_b32 v35, v51, v19
    s_nop 0
    s_waitcnt vmcnt(4)
    v_mfma_f32_16x16x32_bf16 v[20:23], a[16:19], v[32:35], v[20:23]
    s_waitcnt vmcnt(3)
    v_mfma_f32_16x16x32_bf16 v[24:27], a[20:23], v[32:35], v[24:27]
    v_cvt_pk_bf16_f32 v51, v131, v131
    v_and_b32 v28, v51, v16
    v_and_b32 v29, v51, v17
    v_and_b32 v30, v51, v18
    v_and_b32 v31, v51, v19
    s_nop 0
    s_waitcnt vmcnt(2)
    v_mfma_f32_16x16x32_bf16 v[20:23], a[24:27], v[28:31], v[20:23]
    s_waitcnt vmcnt(1)
    v_mfma_f32_16x16x32_bf16 v[24:27], a[28:31], v[28:31], v[24:27]
    buffer_load_dwordx4 a[0:3], v14, s[12:15], s55 offen offset:0 nt
    buffer_load_dwordx4 a[4:7], v14, s[12:15], s55 offen offset:256 nt
    buffer_load_dwordx4 a[8:11], v14, s[12:15], s55 offen offset:2048 nt
    buffer_load_dwordx4 a[12:15], v14, s[12:15], s55 offen offset:2304 nt
    buffer_load_dwordx4 a[16:19], v15, s[12:15], s55 offen offset:0 nt
    buffer_load_dwordx4 a[20:23], v15, s[12:15], s55 offen offset:256 nt
    buffer_load_dwordx4 a[24:27], v15, s[12:15], s55 offen offset:2048 nt
    buffer_load_dwordx4 a[28:31], v15, s[12:15], s55 offen offset:2304 nt
    v_cvt_pk_bf16_f32 v51, v132, v132
    v_and_b32 v32, v51, v16
    v_and_b32 v33, v51, v17
    v_and_b32 v34, v51, v18
    v_and_b32 v35, v51, v19
    s_nop 0
    s_waitcnt vmcnt(7)
    v_mfma_f32_16x16x32_bf16 v[20:23], a[0:3], v[32:35], v[20:23]
    s_waitcnt vmcnt(6)
    v_mfma_f32_16x16x32_bf16 v[24:27], a[4:7], v[32:35], v[24:27]
    v_cvt_pk_bf16_f32 v51, v133, v133
    v_and_b32 v28, v51, v16
    v_and_b32 v29, v51, v17
    v_and_b32 v30, v51, v18
    v_and_b32 v31, v51, v19
    s_nop 0
    s_waitcnt vmcnt(5)
    v_mfma_f32_16x16x32_bf16 v[20:23], a[8:11], v[28:31], v[20:23]
    s_waitcnt vmcnt(4)
    v_mfma_f32_16x16x32_bf16 v[24:27], a[12:15], v[28:31], v[24:27]
    v_cvt_pk_bf16_f32 v51, v134, v134
    v_and_b32 v32, v51, v16
    v_and_b32 v33, v51, v17
    v_and_b32 v34, v51, v18
    v_and_b32 v35, v51, v19
    s_nop 0
    s_waitcnt vmcnt(3)
    v_mfma_f32_16x16x32_bf16 v[20:23], a[16:19], v[32:35], v[20:23]
    s_waitcnt vmcnt(2)
    v_mfma_f32_16x16x32_bf16 v[24:27], a[20:23], v[32:35], v[24:27]
    v_cvt_pk_bf16_f32 v51, v135, v135
    v_and_b32 v28, v51, v16
    v_and_b32 v29, v51, v17
    v_and_b32 v30, v51, v18
    v_and_b32 v31, v51, v19
    s_nop 0
    s_waitcnt vmcnt(1)
    v_mfma_f32_16x16x32_bf16 v[20:23], a[24:27], v[28:31], v[20:23]
    s_waitcnt vmcnt(0)
    v_mfma_f32_16x16x32_bf16 v[24:27], a[28:31], v[28:31], v[24:27]
    buffer_load_dwordx4 a[0:3], v14, s[12:15], s56 offen offset:0 nt
    buffer_load_dwordx4 a[4:7], v14, s[12:15], s56 offen offset:256 nt
    buffer_load_dwordx4 a[8:11], v14, s[12:15], s56 offen offset:2048 nt
    buffer_load_dwordx4 a[12:15], v14, s[12:15], s56 offen offset:2304 nt
    buffer_load_dwordx4 a[16:19], v15, s[12:15], s56 offen offset:0 nt
    buffer_load_dwordx4 a[20:23], v15, s[12:15], s56 offen offset:256 nt
    buffer_load_dwordx4 a[24:27], v15, s[12:15], s56 offen offset:2048 nt
    buffer_load_dwordx4 a[28:31], v15, s[12:15], s56 offen offset:2304 nt
    v_cvt_pk_bf16_f32 v51, v136, v136
    v_and_b32 v32, v51, v16
    v_and_b32 v33, v51, v17
    v_and_b32 v34, v51, v18
    v_and_b32 v35, v51, v19
    s_nop 0
    s_waitcnt vmcnt(7)
    v_mfma_f32_16x16x32_bf16 v[20:23], a[0:3], v[32:35], v[20:23]
    s_waitcnt vmcnt(6)
    v_mfma_f32_16x16x32_bf16 v[24:27], a[4:7], v[32:35], v[24:27]
    v_cvt_pk_bf16_f32 v51, v137, v137
    v_and_b32 v28, v51, v16
    v_and_b32 v29, v51, v17
    v_and_b32 v30, v51, v18
    v_and_b32 v31, v51, v19
    s_nop 0
    s_waitcnt vmcnt(5)
    v_mfma_f32_16x16x32_bf16 v[20:23], a[8:11], v[28:31], v[20:23]
    s_waitcnt vmcnt(4)
    v_mfma_f32_16x16x32_bf16 v[24:27], a[12:15], v[28:31], v[24:27]
    v_cvt_pk_bf16_f32 v51, v138, v138
    v_and_b32 v32, v51, v16
    v_and_b32 v33, v51, v17
    v_and_b32 v34, v51, v18
    v_and_b32 v35, v51, v19
    s_nop 0
    s_waitcnt vmcnt(3)
    v_mfma_f32_16x16x32_bf16 v[20:23], a[16:19], v[32:35], v[20:23]
    s_waitcnt vmcnt(2)
    v_mfma_f32_16x16x32_bf16 v[24:27], a[20:23], v[32:35], v[24:27]
    v_cvt_pk_bf16_f32 v51, v139, v139
    v_and_b32 v28, v51, v16
    v_and_b32 v29, v51, v17
    v_and_b32 v30, v51, v18
    v_and_b32 v31, v51, v19
    s_nop 0
    s_waitcnt vmcnt(1)
    v_mfma_f32_16x16x32_bf16 v[20:23], a[24:27], v[28:31], v[20:23]
    s_waitcnt vmcnt(0)
    v_mfma_f32_16x16x32_bf16 v[24:27], a[28:31], v[28:31], v[24:27]
    buffer_load_dwordx4 a[0:3], v14, s[12:15], s57 offen offset:0 nt
    buffer_load_dwordx4 a[4:7], v14, s[12:15], s57 offen offset:256 nt
    buffer_load_dwordx4 a[8:11], v14, s[12:15], s57 offen offset:2048 nt
    buffer_load_dwordx4 a[12:15], v14, s[12:15], s57 offen offset:2304 nt
    buffer_load_dwordx4 a[16:19], v15, s[12:15], s57 offen offset:0 nt
    buffer_load_dwordx4 a[20:23], v15, s[12:15], s57 offen offset:256 nt
    buffer_load_dwordx4 a[24:27], v15, s[12:15], s57 offen offset:2048 nt
    buffer_load_dwordx4 a[28:31], v15, s[12:15], s57 offen offset:2304 nt
    v_cvt_pk_bf16_f32 v51, v140, v140
    v_and_b32 v32, v51, v16
    v_and_b32 v33, v51, v17
    v_and_b32 v34, v51, v18
    v_and_b32 v35, v51, v19
    s_nop 0
    s_waitcnt vmcnt(7)
    v_mfma_f32_16x16x32_bf16 v[20:23], a[0:3], v[32:35], v[20:23]
    s_waitcnt vmcnt(6)
    v_mfma_f32_16x16x32_bf16 v[24:27], a[4:7], v[32:35], v[24:27]
    v_cvt_pk_bf16_f32 v51, v141, v141
    v_and_b32 v28, v51, v16
    v_and_b32 v29, v51, v17
    v_and_b32 v30, v51, v18
    v_and_b32 v31, v51, v19
    s_nop 0
    s_waitcnt vmcnt(5)
    v_mfma_f32_16x16x32_bf16 v[20:23], a[8:11], v[28:31], v[20:23]
    s_waitcnt vmcnt(4)
    v_mfma_f32_16x16x32_bf16 v[24:27], a[12:15], v[28:31], v[24:27]
    v_cvt_pk_bf16_f32 v51, v142, v142
    v_and_b32 v32, v51, v16
    v_and_b32 v33, v51, v17
    v_and_b32 v34, v51, v18
    v_and_b32 v35, v51, v19
    s_nop 0
    s_waitcnt vmcnt(3)
    v_mfma_f32_16x16x32_bf16 v[20:23], a[16:19], v[32:35], v[20:23]
    s_waitcnt vmcnt(2)
    v_mfma_f32_16x16x32_bf16 v[24:27], a[20:23], v[32:35], v[24:27]
    v_cvt_pk_bf16_f32 v51, v143, v143
    v_and_b32 v28, v51, v16
    v_and_b32 v29, v51, v17
    v_and_b32 v30, v51, v18
    v_and_b32 v31, v51, v19
    s_nop 0
    s_waitcnt vmcnt(1)
    v_mfma_f32_16x16x32_bf16 v[20:23], a[24:27], v[28:31], v[20:23]
    s_waitcnt vmcnt(0)
    v_mfma_f32_16x16x32_bf16 v[24:27], a[28:31], v[28:31], v[24:27]
    buffer_load_dwordx4 a[0:3], v14, s[12:15], s58 offen offset:0 nt
    buffer_load_dwordx4 a[4:7], v14, s[12:15], s58 offen offset:256 nt
    buffer_load_dwordx4 a[8:11], v14, s[12:15], s58 offen offset:2048 nt
    buffer_load_dwordx4 a[12:15], v14, s[12:15], s58 offen offset:2304 nt
    buffer_load_dwordx4 a[16:19], v15, s[12:15], s58 offen offset:0 nt
    buffer_load_dwordx4 a[20:23], v15, s[12:15], s58 offen offset:256 nt
    buffer_load_dwordx4 a[24:27], v15, s[12:15], s58 offen offset:2048 nt
    buffer_load_dwordx4 a[28:31], v15, s[12:15], s58 offen offset:2304 nt
    v_cvt_pk_bf16_f32 v51, v144, v144
    v_and_b32 v32, v51, v16
    v_and_b32 v33, v51, v17
    v_and_b32 v34, v51, v18
    v_and_b32 v35, v51, v19
    s_nop 0
    s_waitcnt vmcnt(7)
    v_mfma_f32_16x16x32_bf16 v[20:23], a[0:3], v[32:35], v[20:23]
    s_waitcnt vmcnt(6)
    v_mfma_f32_16x16x32_bf16 v[24:27], a[4:7], v[32:35], v[24:27]
    v_cvt_pk_bf16_f32 v51, v145, v145
    v_and_b32 v28, v51, v16
    v_and_b32 v29, v51, v17
    v_and_b32 v30, v51, v18
    v_and_b32 v31, v51, v19
    s_nop 0
    s_waitcnt vmcnt(5)
    v_mfma_f32_16x16x32_bf16 v[20:23], a[8:11], v[28:31], v[20:23]
    s_waitcnt vmcnt(4)
    v_mfma_f32_16x16x32_bf16 v[24:27], a[12:15], v[28:31], v[24:27]
    v_cvt_pk_bf16_f32 v51, v146, v146
    v_and_b32 v32, v51, v16
    v_and_b32 v33, v51, v17
    v_and_b32 v34, v51, v18
    v_and_b32 v35, v51, v19
    s_nop 0
    s_waitcnt vmcnt(3)
    v_mfma_f32_16x16x32_bf16 v[20:23], a[16:19], v[32:35], v[20:23]
    s_waitcnt vmcnt(2)
    v_mfma_f32_16x16x32_bf16 v[24:27], a[20:23], v[32:35], v[24:27]
    v_cvt_pk_bf16_f32 v51, v147, v147
    v_and_b32 v28, v51, v16
    v_and_b32 v29, v51, v17
    v_and_b32 v30, v51, v18
    v_and_b32 v31, v51, v19
    s_nop 0
    s_waitcnt vmcnt(1)
    v_mfma_f32_16x16x32_bf16 v[20:23], a[24:27], v[28:31], v[20:23]
    s_waitcnt vmcnt(0)
    v_mfma_f32_16x16x32_bf16 v[24:27], a[28:31], v[28:31], v[24:27]
    buffer_load_dwordx4 a[0:3], v14, s[12:15], s59 offen offset:0 nt
    buffer_load_dwordx4 a[4:7], v14, s[12:15], s59 offen offset:256 nt
    buffer_load_dwordx4 a[8:11], v14, s[12:15], s59 offen offset:2048 nt
    buffer_load_dwordx4 a[12:15], v14, s[12:15], s59 offen offset:2304 nt
    buffer_load_dwordx4 a[16:19], v15, s[12:15], s59 offen offset:0 nt
    buffer_load_dwordx4 a[20:23], v15, s[12:15], s59 offen offset:256 nt
    buffer_load_dwordx4 a[24:27], v15, s[12:15], s59 offen offset:2048 nt
    buffer_load_dwordx4 a[28:31], v15, s[12:15], s59 offen offset:2304 nt
    v_cvt_pk_bf16_f32 v51, v148, v148
    v_and_b32 v32, v51, v16
    v_and_b32 v33, v51, v17
    v_and_b32 v34, v51, v18
    v_and_b32 v35, v51, v19
    s_nop 0
    s_waitcnt vmcnt(7)
    v_mfma_f32_16x16x32_bf16 v[20:23], a[0:3], v[32:35], v[20:23]
    s_waitcnt vmcnt(6)
    v_mfma_f32_16x16x32_bf16 v[24:27], a[4:7], v[32:35], v[24:27]
    v_cvt_pk_bf16_f32 v51, v149, v149
    v_and_b32 v28, v51, v16
    v_and_b32 v29, v51, v17
    v_and_b32 v30, v51, v18
    v_and_b32 v31, v51, v19
    s_nop 0
    s_waitcnt vmcnt(5)
    v_mfma_f32_16x16x32_bf16 v[20:23], a[8:11], v[28:31], v[20:23]
    s_waitcnt vmcnt(4)
    v_mfma_f32_16x16x32_bf16 v[24:27], a[12:15], v[28:31], v[24:27]
    v_cvt_pk_bf16_f32 v51, v150, v150
    v_and_b32 v32, v51, v16
    v_and_b32 v33, v51, v17
    v_and_b32 v34, v51, v18
    v_and_b32 v35, v51, v19
    s_nop 0
    s_waitcnt vmcnt(3)
    v_mfma_f32_16x16x32_bf16 v[20:23], a[16:19], v[32:35], v[20:23]
    s_waitcnt vmcnt(2)
    v_mfma_f32_16x16x32_bf16 v[24:27], a[20:23], v[32:35], v[24:27]
    v_cvt_pk_bf16_f32 v51, v151, v151
    v_and_b32 v28, v51, v16
    v_and_b32 v29, v51, v17
    v_and_b32 v30, v51, v18
    v_and_b32 v31, v51, v19
    s_nop 0
    s_waitcnt vmcnt(1)
    v_mfma_f32_16x16x32_bf16 v[20:23], a[24:27], v[28:31], v[20:23]
    s_waitcnt vmcnt(0)
    v_mfma_f32_16x16x32_bf16 v[24:27], a[28:31], v[28:31], v[24:27]
    buffer_load_dwordx4 a[0:3], v14, s[12:15], s60 offen offset:0 nt
    buffer_load_dwordx4 a[4:7], v14, s[12:15], s60 offen offset:256 nt
    buffer_load_dwordx4 a[8:11], v14, s[12:15], s60 offen offset:2048 nt
    buffer_load_dwordx4 a[12:15], v14, s[12:15], s60 offen offset:2304 nt
    buffer_load_dwordx4 a[16:19], v15, s[12:15], s60 offen offset:0 nt
    buffer_load_dwordx4 a[20:23], v15, s[12:15], s60 offen offset:256 nt
    buffer_load_dwordx4 a[24:27], v15, s[12:15], s60 offen offset:2048 nt
    buffer_load_dwordx4 a[28:31], v15, s[12:15], s60 offen offset:2304 nt
    v_cvt_pk_bf16_f32 v51, v152, v152
    v_and_b32 v32, v51, v16
    v_and_b32 v33, v51, v17
    v_and_b32 v34, v51, v18
    v_and_b32 v35, v51, v19
    s_nop 0
    s_waitcnt vmcnt(7)
    v_mfma_f32_16x16x32_bf16 v[20:23], a[0:3], v[32:35], v[20:23]
    s_waitcnt vmcnt(6)
    v_mfma_f32_16x16x32_bf16 v[24:27], a[4:7], v[32:35], v[24:27]
    v_cvt_pk_bf16_f32 v51, v153, v153
    v_and_b32 v28, v51, v16
    v_and_b32 v29, v51, v17
    v_and_b32 v30, v51, v18
    v_and_b32 v31, v51, v19
    s_nop 0
    s_waitcnt vmcnt(5)
    v_mfma_f32_16x16x32_bf16 v[20:23], a[8:11], v[28:31], v[20:23]
    s_waitcnt vmcnt(4)
    v_mfma_f32_16x16x32_bf16 v[24:27], a[12:15], v[28:31], v[24:27]
    s_add_u32 s48, s45, 2097152
    s_add_u32 s49, s46, 2097152
    s_mov_b32 exec_hi, 0
    buffer_load_dwordx4 v[56:59], v46, s[16:19], s48 offen sc1
    s_mov_b64 exec, 1
    buffer_load_dwordx2 v[60:61], v45, s[16:19], s49 offen sc1
    s_mov_b64 exec, -1
    v_cvt_pk_bf16_f32 v51, v154, v154
    v_and_b32 v32, v51, v16
    v_and_b32 v33, v51, v17
    v_and_b32 v34, v51, v18
    v_and_b32 v35, v51, v19
    s_nop 0
    s_waitcnt vmcnt(5)
    v_mfma_f32_16x16x32_bf16 v[20:23], a[16:19], v[32:35], v[20:23]
    s_waitcnt vmcnt(4)
    v_mfma_f32_16x16x32_bf16 v[24:27], a[20:23], v[32:35], v[24:27]
    v_cvt_pk_bf16_f32 v51, v155, v155
    v_and_b32 v28, v51, v16
    v_and_b32 v29, v51, v17
    v_and_b32 v30, v51, v18
    v_and_b32 v31, v51, v19
    s_nop 0
    s_waitcnt vmcnt(3)
    v_mfma_f32_16x16x32_bf16 v[20:23], a[24:27], v[28:31], v[20:23]
    s_waitcnt vmcnt(2)
    v_mfma_f32_16x16x32_bf16 v[24:27], a[28:31], v[28:31], v[24:27]
    buffer_load_dwordx4 a[0:3], v14, s[12:15], s61 offen offset:0 nt
    buffer_load_dwordx4 a[4:7], v14, s[12:15], s61 offen offset:256 nt
    buffer_load_dwordx4 a[8:11], v14, s[12:15], s61 offen offset:2048 nt
    buffer_load_dwordx4 a[12:15], v14, s[12:15], s61 offen offset:2304 nt
    buffer_load_dwordx4 a[16:19], v15, s[12:15], s61 offen offset:0 nt
    buffer_load_dwordx4 a[20:23], v15, s[12:15], s61 offen offset:256 nt
    buffer_load_dwordx4 a[24:27], v15, s[12:15], s61 offen offset:2048 nt
    buffer_load_dwordx4 a[28:31], v15, s[12:15], s61 offen offset:2304 nt
    v_mov_b32 v53, 0x2000000
    s_mov_b64 exec, 1
    buffer_atomic_add v53, v54, s[24:27], 0 offen sc0
    s_mov_b64 exec, -1
    v_cvt_pk_bf16_f32 v51, v156, v156
    v_and_b32 v32, v51, v16
    v_and_b32 v33, v51, v17
    v_and_b32 v34, v51, v18
    v_and_b32 v35, v51, v19
    s_nop 0
    s_waitcnt vmcnt(8)
    v_mfma_f32_16x16x32_bf16 v[20:23], a[0:3], v[32:35], v[20:23]
    s_waitcnt vmcnt(7)
    v_mfma_f32_16x16x32_bf16 v[24:27], a[4:7], v[32:35], v[24:27]
    v_cvt_pk_bf16_f32 v51, v157, v157
    v_and_b32 v28, v51, v16
    v_and_b32 v29, v51, v17
    v_and_b32 v30, v51, v18
    v_and_b32 v31, v51, v19
    s_nop 0
    s_waitcnt vmcnt(6)
    v_mfma_f32_16x16x32_bf16 v[20:23], a[8:11], v[28:31], v[20:23]
    s_waitcnt vmcnt(5)
    v_mfma_f32_16x16x32_bf16 v[24:27], a[12:15], v[28:31], v[24:27]
    v_cvt_pk_bf16_f32 v51, v158, v158
    v_and_b32 v32, v51, v16
    v_and_b32 v33, v51, v17
    v_and_b32 v34, v51, v18
    v_and_b32 v35, v51, v19
    s_nop 0
    s_waitcnt vmcnt(4)
    v_mfma_f32_16x16x32_bf16 v[20:23], a[16:19], v[32:35], v[20:23]
    s_waitcnt vmcnt(3)
    v_mfma_f32_16x16x32_bf16 v[24:27], a[20:23], v[32:35], v[24:27]
    v_cvt_pk_bf16_f32 v51, v159, v159
    v_and_b32 v28, v51, v16
    v_and_b32 v29, v51, v17
    v_and_b32 v30, v51, v18
    v_and_b32 v31, v51, v19
    s_nop 0
    s_waitcnt vmcnt(2)
    v_mfma_f32_16x16x32_bf16 v[20:23], a[24:27], v[28:31], v[20:23]
    s_waitcnt vmcnt(1)
    v_mfma_f32_16x16x32_bf16 v[24:27], a[28:31], v[28:31], v[24:27]
    s_branch L_join
L_body1:
    s_cmp_lg_u32 s44, 0
    s_cbranch_scc1 L_notree1b
    s_waitcnt vmcnt(8)
    v_mfma_f32_16x16x32_bf16 v[36:39], v[96:99], v[64:67], 0
    v_mfma_f32_16x16x32_bf16 v[36:39], v[100:103], v[68:71], v[36:39]
    v_mfma_f32_16x16x32_bf16 v[36:39], v[104:107], v[72:75], v[36:39]
    v_mfma_f32_16x16x32_bf16 v[36:39], v[108:111], v[76:79], v[36:39]
    v_mfma_f32_16x16x32_bf16 v[36:39], v[112:115], v[80:83], v[36:39]
    v_mfma_f32_16x16x32_bf16 v[36:39], v[116:119], v[84:87], v[36:39]
    v_mfma_f32_16x16x32_bf16 v[36:39], v[120:123], v[88:91], v[36:39]
    v_mfma_f32_16x16x32_bf16 v[36:39], v[124:127], v[92:95], v[36:39]
    v_lshlrev_b32 v47, 16, v47
    v_sub_f32 v47, 1.0, v47
    s_mov_b32 s46, 0xd06e6b28
    v_cmp_gt_u32 vcc, 16, v1
    v_mov_b32 v50, 0xff800000
    s_nop 4
    v_fma_f32 v36, v47, s46, v36
    v_cndmask_b32 v36, v50, v36, vcc
L_notree1b:
    s_waitcnt vmcnt(8)
    ds_read_b128 v[96:99], v10 offset:0
    ds_read_b128 v[100:103], v11 offset:0
    ds_read_b128 v[104:107], v12 offset:0
    ds_read_b128 v[108:111], v13 offset:0
    ds_read_b128 v[112:115], v10 offset:256
    ds_read_b128 v[116:119], v11 offset:256
    ds_read_b128 v[120:123], v12 offset:256
    ds_read_b128 v[124:127], v13 offset:256
    s_waitcnt lgkmcnt(7)
    v_mfma_f32_16x16x32_bf16 v[128:131], v[96:99], v[64:67], 0
    s_waitcnt lgkmcnt(6)
    v_mfma_f32_16x16x32_bf16 v[128:131], v[100:103], v[68:71], v[128:131]
    s_waitcnt lgkmcnt(5)
    v_mfma_f32_16x16x32_bf16 v[128:131], v[104:107], v[72:75], v[128:131]
    s_waitcnt lgkmcnt(4)
    v_mfma_f32_16x16x32_bf16 v[128:131], v[108:111], v[76:79], v[128:131]
    s_waitcnt lgkmcnt(3)
    v_mfma_f32_16x16x32_bf16 v[128:131], v[112:115], v[80:83], v[128:131]
    s_waitcnt lgkmcnt(2)
    v_mfma_f32_16x16x32_bf16 v[128:131], v[116:119], v[84:87], v[128:131]
    s_waitcnt lgkmcnt(1)
    v_mfma_f32_16x16x32_bf16 v[128:131], v[120:123], v[88:91], v[128:131]
    s_waitcnt lgkmcnt(0)
    v_mfma_f32_16x16x32_bf16 v[128:131], v[124:127], v[92:95], v[128:131]
    s_add_u32 m0, s53, 0
    s_nop 0
    buffer_load_dwordx4 v2, s[8:11], s56 offen offset:0 nt lds
    buffer_load_dwordx4 v3, s[8:11], s56 offen offset:1024 nt lds
    buffer_load_dwordx4 v4, s[8:11], s56 offen offset:2048 nt lds
    buffer_load_dwordx4 v5, s[8:11], s56 offen offset:3072 nt lds
    s_add_u32 m0, s53, 4096
    s_nop 0
    buffer_load_dwordx4 v6, s[8:11], s56 offen offset:0 nt lds
    buffer_load_dwordx4 v7, s[8:11], s56 offen offset:1024 nt lds
    buffer_load_dwordx4 v8, s[8:11], s56 offen offset:2048 nt lds
    buffer_load_dwordx4 v9, s[8:11], s56 offen offset:3072 nt lds
    s_waitcnt vmcnt(8)
    ds_read_b128 v[96:99], v10 offset:8192
    ds_read_b128 v[100:103], v11 offset:8192
    ds_read_b128 v[104:107], v12 offset:8192
    ds_read_b128 v[108:111], v13 offset:8192
    ds_read_b128 v[112:115], v10 offset:8448
    ds_read_b128 v[116:119], v11 offset:8448
    ds_read_b128 v[120:123], v12 offset:8448
    ds_read_b128 v[124:127], v13 offset:8448
    s_waitcnt lgkmcnt(7)
    v_mfma_f32_16x16x32_bf16 v[132:135], v[96:99], v[64:67], 0
    s_waitcnt lgkmcnt(6)
    v_mfma_f32_16x16x32_bf16 v[132:135], v[100:103], v[68:71], v[132:135]
    s_waitcnt lgkmcnt(5)
    v_mfma_f32_16x16x32_bf16 v[132:135], v[104:107], v[72:75], v[132:135]
    s_waitcnt lgkmcnt(4)
    v_mfma_f32_16x16x32_bf16 v[132:135], v[108:111], v[76:79], v[132:135]
    s_waitcnt lgkmcnt(3)
    v_mfma_f32_16x16x32_bf16 v[132:135], v[112:115], v[80:83], v[132:135]
    s_waitcnt lgkmcnt(2)
    v_mfma_f32_16x16x32_bf16 v[132:135], v[116:119], v[84:87], v[132:135]
    s_waitcnt lgkmcnt(1)
    v_mfma_f32_16x16x32_bf16 v[132:135], v[120:123], v[88:91], v[132:135]
    s_waitcnt lgkmcnt(0)
    v_mfma_f32_16x16x32_bf16 v[132:135], v[124:127], v[92:95], v[132:135]
    s_add_u32 m0, s53, 8192
    s_nop 0
    buffer_load_dwordx4 v2, s[8:11], s57 offen offset:0 nt lds
    buffer_load_dwordx4 v3, s[8:11], s57 offen offset:1024 nt lds
    buffer_load_dwordx4 v4, s[8:11], s57 offen offset:2048 nt lds
    buffer_load_dwordx4 v5, s[8:11], s57 offen offset:3072 nt lds
    s_add_u32 m0, s53, 12288
    s_nop 0
    buffer_load_dwordx4 v6, s[8:11], s57 offen offset:0 nt lds
    buffer_load_dwordx4 v7, s[8:11], s57 offen offset:1024 nt lds
    buffer_load_dwordx4 v8, s[8:11], s57 offen offset:2048 nt lds
    buffer_load_dwordx4 v9, s[8:11], s57 offen offset:3072 nt lds
    s_waitcnt vmcnt(8)
    ds_read_b128 v[96:99], v10 offset:0
    ds_read_b128 v[100:103], v11 offset:0
    ds_read_b128 v[104:107], v12 offset:0
    ds_read_b128 v[108:111], v13 offset:0
    ds_read_b128 v[112:115], v10 offset:256
    ds_read_b128 v[116:119], v11 offset:256
    ds_read_b128 v[120:123], v12 offset:256
    ds_read_b128 v[124:127], v13 offset:256
    s_waitcnt lgkmcnt(7)
    v_mfma_f32_16x16x32_bf16 v[136:139], v[96:99], v[64:67], 0
    s_waitcnt lgkmcnt(6)
    v_mfma_f32_16x16x32_bf16 v[136:139], v[100:103], v[68:71], v[136:139]
    s_waitcnt lgkmcnt(5)
    v_mfma_f32_16x16x32_bf16 v[136:139], v[104:107], v[72:75], v[136:139]
    s_waitcnt lgkmcnt(4)
    v_mfma_f32_16x16x32_bf16 v[136:139], v[108:111], v[76:79], v[136:139]
    s_waitcnt lgkmcnt(3)
    v_mfma_f32_16x16x32_bf16 v[136:139], v[112:115], v[80:83], v[136:139]
    s_waitcnt lgkmcnt(2)
    v_mfma_f32_16x16x32_bf16 v[136:139], v[116:119], v[84:87], v[136:139]
    s_waitcnt lgkmcnt(1)
    v_mfma_f32_16x16x32_bf16 v[136:139], v[120:123], v[88:91], v[136:139]
    s_waitcnt lgkmcnt(0)
    v_mfma_f32_16x16x32_bf16 v[136:139], v[124:127], v[92:95], v[136:139]
    s_add_u32 m0, s53, 0
    s_nop 0
    buffer_load_dwordx4 v2, s[8:11], s58 offen offset:0 nt lds
    buffer_load_dwordx4 v3, s[8:11], s58 offen offset:1024 nt lds
    buffer_load_dwordx4 v4, s[8:11], s58 offen offset:2048 nt lds
    buffer_load_dwordx4 v5, s[8:11], s58 offen offset:3072 nt lds
    s_add_u32 m0, s53, 4096
    s_nop 0
    buffer_load_dwordx4 v6, s[8:11], s58 offen offset:0 nt lds
    buffer_load_dwordx4 v7, s[8:11], s58 offen offset:1024 nt lds
    buffer_load_dwordx4 v8, s[8:11], s58 offen offset:2048 nt lds
    buffer_load_dwordx4 v9, s[8:11], s58 offen offset:3072 nt lds
    s_waitcnt vmcnt(8)
    ds_read_b128 v[96:99], v10 offset:8192
    ds_read_b128 v[100:103], v11 offset:8192
    ds_read_b128 v[104:107], v12 offset:8192
    ds_read_b128 v[108:111], v13 offset:8192
    ds_read_b128 v[112:115], v10 offset:8448
    ds_read_b128 v[116:119], v11 offset:8448
    ds_read_b128 v[120:123], v12 offset:8448
    ds_read_b128 v[124:127], v13 offset:8448
    s_waitcnt lgkmcnt(7)
    v_mfma_f32_16x16x32_bf16 v[140:143], v[96:99], v[64:67], 0
    s_waitcnt lgkmcnt(6)
    v_mfma_f32_16x16x32_bf16 v[140:143], v[100:103], v[68:71], v[140:143]
    s_waitcnt lgkmcnt(5)
    v_mfma_f32_16x16x32_bf16 v[140:143], v[104:107], v[72:75], v[140:143]
    s_waitcnt lgkmcnt(4)
    v_mfma_f32_16x16x32_bf16 v[140:143], v[108:111], v[76:79], v[140:143]
    s_waitcnt lgkmcnt(3)
    v_mfma_f32_16x16x32_bf16 v[140:143], v[112:115], v[80:83], v[140:143]
    s_waitcnt lgkmcnt(2)
    v_mfma_f32_16x16x32_bf16 v[140:143], v[116:119], v[84:87], v[140:143]
    s_waitcnt lgkmcnt(1)
    v_mfma_f32_16x16x32_bf16 v[140:143], v[120:123], v[88:91], v[140:143]
    s_waitcnt lgkmcnt(0)
    v_mfma_f32_16x16x32_bf16 v[140:143], v[124:127], v[92:95], v[140:143]
    s_add_u32 m0, s53, 8192
    s_nop 0
    buffer_load_dwordx4 v2, s[8:11], s59 offen offset:0 nt lds
    buffer_load_dwordx4 v3, s[8:11], s59 offen offset:1024 nt lds
    buffer_load_dwordx4 v4, s[8:11], s59 offen offset:2048 nt lds
    buffer_load_dwordx4 v5, s[8:11], s59 offen offset:3072 nt lds
    s_add_u32 m0, s53, 12288
    s_nop 0
    buffer_load_dwordx4 v6, s[8:11], s59 offen offset:0 nt lds
    buffer_load_dwordx4 v7, s[8:11], s59 offen offset:1024 nt lds
    buffer_load_dwordx4 v8, s[8:11], s59 offen offset:2048 nt lds
    buffer_load_dwordx4 v9, s[8:11], s59 offen offset:3072 nt lds
    s_waitcnt vmcnt(8)
    ds_read_b128 v[96:99], v10 offset:0
    ds_read_b128 v[100:103], v11 offset:0
    ds_read_b128 v[104:107], v12 offset:0
    ds_read_b128 v[108:111], v13 offset:0
    ds_read_b128 v[112:115], v10 offset:256
    ds_read_b128 v[116:119], v11 offset:256
    ds_read_b128 v[120:123], v12 offset:256
    ds_read_b128 v[124:127], v13 offset:256
    s_waitcnt lgkmcnt(7)
    v_mfma_f32_16x16x32_bf16 v[144:147], v[96:99], v[64:67], 0
    s_waitcnt lgkmcnt(6)
    v_mfma_f32_16x16x32_bf16 v[144:147], v[100:103], v[68:71], v[144:147]
    s_waitcnt lgkmcnt(5)
    v_mfma_f32_16x16x32_bf16 v[144:147], v[104:107], v[72:75], v[144:147]
    s_waitcnt lgkmcnt(4)
    v_mfma_f32_16x16x32_bf16 v[144:147], v[108:111], v[76:79], v[144:147]
    s_waitcnt lgkmcnt(3)
    v_mfma_f32_16x16x32_bf16 v[144:147], v[112:115], v[80:83], v[144:147]
    s_waitcnt lgkmcnt(2)
    v_mfma_f32_16x16x32_bf16 v[144:147], v[116:119], v[84:87], v[144:147]
    s_waitcnt lgkmcnt(1)
    v_mfma_f32_16x16x32_bf16 v[144:147], v[120:123], v[88:91], v[144:147]
    s_waitcnt lgkmcnt(0)
    v_mfma_f32_16x16x32_bf16 v[144:147], v[124:127], v[92:95], v[144:147]
    s_add_u32 m0, s53, 0
    s_nop 0
    buffer_load_dwordx4 v2, s[8:11], s60 offen offset:0 nt lds
    buffer_load_dwordx4 v3, s[8:11], s60 offen offset:1024 nt lds
    buffer_load_dwordx4 v4, s[8:11], s60 offen offset:2048 nt lds
    buffer_load_dwordx4 v5, s[8:11], s60 offen offset:3072 nt lds
    s_add_u32 m0, s53, 4096
    s_nop 0
    buffer_load_dwordx4 v6, s[8:11], s60 offen offset:0 nt lds
    buffer_load_dwordx4 v7, s[8:11], s60 offen offset:1024 nt lds
    buffer_load_dwordx4 v8, s[8:11], s60 offen offset:2048 nt lds
    buffer_load_dwordx4 v9, s[8:11], s60 offen offset:3072 nt lds
    s_waitcnt vmcnt(8)
    ds_read_b128 v[96:99], v10 offset:8192
    ds_read_b128 v[100:103], v11 offset:8192
    ds_read_b128 v[104:107], v12 offset:8192
    ds_read_b128 v[108:111], v13 offset:8192
    ds_read_b128 v[112:115], v10 offset:8448
    ds_read_b128 v[116:119], v11 offset:8448
    ds_read_b128 v[120:123], v12 offset:8448
    ds_read_b128 v[124:127], v13 offset:8448
    s_waitcnt lgkmcnt(7)
    v_mfma_f32_16x16x32_bf16 v[148:151], v[96:99], v[64:67], 0
    s_waitcnt lgkmcnt(6)
    v_mfma_f32_16x16x32_bf16 v[148:151], v[100:103], v[68:71], v[148:151]
    s_waitcnt lgkmcnt(5)
    v_mfma_f32_16x16x32_bf16 v[148:151], v[104:107], v[72:75], v[148:151]
    s_waitcnt lgkmcnt(4)
    v_mfma_f32_16x16x32_bf16 v[148:151], v[108:111], v[76:79], v[148:151]
    s_waitcnt lgkmcnt(3)
    v_mfma_f32_16x16x32_bf16 v[148:151], v[112:115], v[80:83], v[148:151]
    s_waitcnt lgkmcnt(2)
    v_mfma_f32_16x16x32_bf16 v[148:151], v[116:119], v[84:87], v[148:151]
    s_waitcnt lgkmcnt(1)
    v_mfma_f32_16x16x32_bf16 v[148:151], v[120:123], v[88:91], v[148:151]
    s_waitcnt lgkmcnt(0)
    v_mfma_f32_16x16x32_bf16 v[148:151], v[124:127], v[92:95], v[148:151]
    s_add_u32 m0, s53, 8192
    s_nop 0
    buffer_load_dwordx4 v2, s[8:11], s61 offen offset:0 nt lds
    buffer_load_dwordx4 v3, s[8:11], s61 offen offset:1024 nt lds
    buffer_load_dwordx4 v4, s[8:11], s61 offen offset:2048 nt lds
    buffer_load_dwordx4 v5, s[8:11], s61 offen offset:3072 nt lds
    s_add_u32 m0, s53, 12288
    s_nop 0
    buffer_load_dwordx4 v6, s[8:11], s61 offen offset:0 nt lds
    buffer_load_dwordx4 v7, s[8:11], s61 offen offset:1024 nt lds
    buffer_load_dwordx4 v8, s[8:11], s61 offen offset:2048 nt lds
    buffer_load_dwordx4 v9, s[8:11], s61 offen offset:3072 nt lds
    s_waitcnt vmcnt(8)
    ds_read_b128 v[96:99], v10 offset:0
    ds_read_b128 v[100:103], v11 offset:0
    ds_read_b128 v[104:107], v12 offset:0
    ds_read_b128 v[108:111], v13 offset:0
    ds_read_b128 v[112:115], v10 offset:256
    ds_read_b128 v[116:119], v11 offset:256
    ds_read_b128 v[120:123], v12 offset:256
    ds_read_b128 v[124:127], v13 offset:256
    s_waitcnt lgkmcnt(7)
    v_mfma_f32_16x16x32_bf16 v[152:155], v[96:99], v[64:67], 0
    s_waitcnt lgkmcnt(6)
    v_mfma_f32_16x16x32_bf16 v[152:155], v[100:103], v[68:71], v[152:155]
    s_waitcnt lgkmcnt(5)
    v_mfma_f32_16x16x32_bf16 v[152:155], v[104:107], v[72:75], v[152:155]
    s_waitcnt lgkmcnt(4)
    v_mfma_f32_16x16x32_bf16 v[152:155], v[108:111], v[76:79], v[152:155]
    s_waitcnt lgkmcnt(3)
    v_mfma_f32_16x16x32_bf16 v[152:155], v[112:115], v[80:83], v[152:155]
    s_waitcnt lgkmcnt(2)
    v_mfma_f32_16x16x32_bf16 v[152:155], v[116:119], v[84:87], v[152:155]
    s_waitcnt lgkmcnt(1)
    v_mfma_f32_16x16x32_bf16 v[152:155], v[120:123], v[88:91], v[152:155]
    s_waitcnt lgkmcnt(0)
    v_mfma_f32_16x16x32_bf16 v[152:155], v[124:127], v[92:95], v[152:155]
    buffer_load_dwordx4 a[0:3], v14, s[12:15], s54 offen offset:0 nt
    buffer_load_dwordx4 a[4:7], v14, s[12:15], s54 offen offset:256 nt
    buffer_load_dwordx4 a[8:11], v14, s[12:15], s54 offen offset:2048 nt
    buffer_load_dwordx4 a[12:15], v14, s[12:15], s54 offen offset:2304 nt
    buffer_load_dwordx4 a[16:19], v15, s[12:15], s54 offen offset:0 nt
    buffer_load_dwordx4 a[20:23], v15, s[12:15], s54 offen offset:256 nt
    buffer_load_dwordx4 a[24:27], v15, s[12:15], s54 offen offset:2048 nt
    buffer_load_dwordx4 a[28:31], v15, s[12:15], s54 offen offset:2304 nt
    s_waitcnt vmcnt(8)
    ds_read_b128 v[96:99], v10 offset:8192
    ds_read_b128 v[100:103], v11 offset:8192
    ds_read_b128 v[104:107], v12 offset:8192
    ds_read_b128 v[108:111], v13 offset:8192
    ds_read_b128 v[112:115], v10 offset:8448
    ds_read_b128 v[116:119], v11 offset:8448
    ds_read_b128 v[120:123], v12 offset:8448
    ds_read_b128 v[124:127], v13 offset:8448
    s_waitcnt lgkmcnt(7)
    v_mfma_f32_16x16x32_bf16 v[156:159], v[96:99], v[64:67], 0
    s_waitcnt lgkmcnt(6)
    v_mfma_f32_16x16x32_bf16 v[156:159], v[100:103], v[68:71], v[156:159]
    s_waitcnt lgkmcnt(5)
    v_mfma_f32_16x16x32_bf16 v[156:159], v[104:107], v[72:75], v[156:159]
    s_waitcnt lgkmcnt(4)
    v_mfma_f32_16x16x32_bf16 v[156:159], v[108:111], v[76:79], v[156:159]
    s_waitcnt lgkmcnt(3)
    v_mfma_f32_16x16x32_bf16 v[156:159], v[112:115], v[80:83], v[156:159]
    s_waitcnt lgkmcnt(2)
    v_mfma_f32_16x16x32_bf16 v[156:159], v[116:119], v[84:87], v[156:159]
    s_waitcnt lgkmcnt(1)
    v_mfma_f32_16x16x32_bf16 v[156:159], v[120:123], v[88:91], v[156:159]
    s_waitcnt lgkmcnt(0)
    v_mfma_f32_16x16x32_bf16 v[156:159], v[124:127], v[92:95], v[156:159]
    buffer_load_dwordx4 a[32:35], v14, s[12:15], s55 offen offset:0 nt
    buffer_load_dwordx4 a[36:39], v14, s[12:15], s55 offen offset:256 nt
    buffer_load_dwordx4 a[40:43], v14, s[12:15], s55 offen offset:2048 nt
    buffer_load_dwordx4 a[44:47], v14, s[12:15], s55 offen offset:2304 nt
    buffer_load_dwordx4 a[48:51], v15, s[12:15], s55 offen offset:0 nt
    buffer_load_dwordx4 a[52:55], v15, s[12:15], s55 offen offset:256 nt
    buffer_load_dwordx4 a[56:59], v15, s[12:15], s55 offen offset:2048 nt
    buffer_load_dwordx4 a[60:63], v15, s[12:15], s55 offen offset:2304 nt
    v_max3_f32 v50, v128, v129, v36
    v_max3_f32 v50, v130, v131, v50
    v_max3_f32 v50, v132, v133, v50
    v_max3_f32 v50, v134, v135, v50
    v_max3_f32 v50, v136, v137, v50
    v_max3_f32 v50, v138, v139, v50
    v_max3_f32 v50, v140, v141, v50
    v_max3_f32 v50, v142, v143, v50
    v_max3_f32 v50, v144, v145, v50
    v_max3_f32 v50, v146, v147, v50
    v_max3_f32 v50, v148, v149, v50
    v_max3_f32 v50, v150, v151, v50
    v_max3_f32 v50, v152, v153, v50
    v_max3_f32 v50, v154, v155, v50
    v_bfe_u32 v40, v1, 3, 1
    v_lshlrev_b32 v40, 4, v40
    s_lshl_b32 s45, s42, 2
    v_add_u32 v41, s45, v40
    s_nop 3
    v_max3_f32 v50, v156, v157, v50
    v_max3_f32 v50, v158, v159, v50
    v_mov_b32 v51, v50
    s_nop 1
    v_permlane16_swap_b32 v50, v51
    v_max_f32 v50, v50, v51
    v_mov_b32 v51, v50
    s_nop 1
    v_permlane32_swap_b32 v50, v51
    v_max_f32 v50, v50, v51
    s_mov_b64 exec, 0x101
    ds_write_b32 v41, v50 offset:8192
    s_mov_b64 exec, -1
    s_waitcnt lgkmcnt(0)
    s_barrier
    ds_read_b128 v[28:31], v40 offset:8192
    v_mov_b32 v52, s94
    s_mov_b64 exec, 1
    buffer_atomic_add v52, v54, s[24:27], 0 offen
    s_mov_b64 exec, -1
    s_waitcnt lgkmcnt(0)
    v_max3_f32 v50, v28, v29, v30
    v_max_f32 v50, v50, v31
    v_mul_f32 v48, s43, v50
    v_fma_f32 v36, v36, s43, -v48
    v_fma_f32 v128, v128, s43, -v48
    v_fma_f32 v129, v129, s43, -v48
    v_fma_f32 v130, v130, s43, -v48
    v_fma_f32 v131, v131, s43, -v48
    v_fma_f32 v132, v132, s43, -v48
    v_fma_f32 v133, v133, s43, -v48
    v_fma_f32 v134, v134, s43, -v48
    v_fma_f32 v135, v135, s43, -v48
    v_fma_f32 v136, v136, s43, -v48
    v_fma_f32 v137, v137, s43, -v48
    v_fma_f32 v138, v138, s43, -v48
    v_fma_f32 v139, v139, s43, -v48
    v_fma_f32 v140, v140, s43, -v48
    v_fma_f32 v141, v141, s43, -v48
    v_fma_f32 v142, v142, s43, -v48
    v_fma_f32 v143, v143, s43, -v48
    v_fma_f32 v144, v144, s43, -v48
    v_fma_f32 v145, v145, s43, -v48
    v_fma_f32 v146, v146, s43, -v48
    v_fma_f32 v147, v147, s43, -v48
    v_fma_f32 v148, v148, s43, -v48
    v_fma_f32 v149, v149, s43, -v48
    v_fma_f32 v150, v150, s43, -v48
    v_fma_f32 v151, v151, s43, -v48
    v_fma_f32 v152, v152, s43, -v48
    v_fma_f32 v153, v153, s43, -v48
    v_fma_f32 v154, v154, s43, -v48
    v_fma_f32 v155, v155, s43, -v48
    v_fma_f32 v156, v156, s43, -v48
    v_fma_f32 v157, v157, s43, -v48
    v_fma_f32 v158, v158, s43, -v48
    v_fma_f32 v159, v159, s43, -v48
    v_exp_f32 v36, v36
    v_exp_f32 v128, v128
    v_exp_f32 v129, v129
    v_exp_f32 v130, v130
    v_exp_f32 v131, v131
    v_exp_f32 v132, v132
    v_exp_f32 v133, v133
    v_exp_f32 v134, v134
    v_exp_f32 v135, v135
    v_exp_f32 v136, v136
    v_exp_f32 v137, v137
    v_exp_f32 v138, v138
    v_exp_f32 v139, v139
    v_exp_f32 v140, v140
    v_exp_f32 v141, v141
    v_exp_f32 v142, v142
    v_exp_f32 v143, v143
    v_exp_f32 v144, v144
    v_exp_f32 v145, v145
    v_exp_f32 v146, v146
    v_exp_f32 v147, v147
    v_exp_f32 v148, v148
    v_exp_f32 v149, v149
    v_exp_f32 v150, v150
    v_exp_f32 v151, v151
    v_exp_f32 v152, v152
    v_exp_f32 v153, v153
    v_exp_f32 v154, v154
    v_exp_f32 v155, v155
    v_exp_f32 v156, v156
    v_exp_f32 v157, v157
    v_exp_f32 v158, v158
    v_exp_f32 v159, v159
    v_add_f32 v49, v36, v128
    v_add_f32 v50, v129, v130
    v_add_f32 v49, v49, v131
    v_add_f32 v50, v50, v132
    v_add_f32 v49, v49, v133
    v_add_f32 v50, v50, v134
    v_add_f32 v49, v49, v135
    v_add_f32 v50, v50, v136
    v_add_f32 v49, v49, v137
    v_add_f32 v50, v50, v138
    v_add_f32 v49, v49, v139
    v_add_f32 v50, v50, v140
    v_add_f32 v49, v49, v141
    v_add_f32 v50, v50, v142
    v_add_f32 v49, v49, v143
    v_add_f32 v50, v50, v144
    v_add_f32 v49, v49, v145
    v_add_f32 v50, v50, v146
    v_add_f32 v49, v49, v147
    v_add_f32 v50, v50, v148
    v_add_f32 v49, v49, v149
    v_add_f32 v50, v50, v150
    v_add_f32 v49, v49, v151
    v_add_f32 v50, v50, v152
    v_add_f32 v49, v49, v153
    v_add_f32 v50, v50, v154
    v_add_f32 v49, v49, v155
    v_add_f32 v50, v50, v156
    v_add_f32 v49, v49, v157
    v_add_f32 v50, v50, v158
    v_add_f32 v49, v49, v159
    v_add_f32 v49, v49, v50
    v_mov_b32 v51, v49
    s_nop 1
    v_permlane16_swap_b32 v49, v51
    v_add_f32 v49, v49, v51
    v_mov_b32 v51, v49
    s_nop 1
    v_permlane32_swap_b32 v49, v51
    v_add_f32 v49, v49, v51
    s_mov_b64 exec, 0x101
    ds_write_b32 v41, v49 offset:8224
    s_mov_b64 exec, -1
    s_lshr_b32 s46, s42, 1
    s_lshl_b32 s47, s46, 3
    s_nop 0
    v_readlane_b32 s93, v48, s47
    v_lshrrev_b32 v41, 5, v1
    v_lshlrev_b32 v41, 7, v41
    v_bfe_u32 v44, v1, 4, 1
    v_lshl_add_u32 v41, v44, 6, v41
    v_bfe_u32 v44, v1, 2, 2
    v_lshl_add_u32 v41, v44, 4, v41
    v_and_b32 v44, 3, v1
    v_lshl_add_u32 v41, v44, 2, v41
    s_lshl_b32 s45, s42, 11
    v_add_u32 v41, s45, v41
    v_bfe_u32 v42, v1, 1, 2
    v_lshlrev_b32 v42, 8, v42
    v_bfe_u32 v44, v1, 3, 2
    v_lshl_add_u32 v42, v44, 6, v42
    v_and_b32 v44, 1, v1
    v_lshl_add_u32 v42, v44, 4, v42
    s_and_b32 s45, s42, 1
    s_lshl_b32 s45, s45, 10
    s_lshl_b32 s47, s46, 5
    s_add_u32 s45, s45, s47
    v_add_u32 v42, s45, v42
    s_lshl_b32 s47, s46, 4
    v_mov_b32 v43, s47
    v_mov_b32 v45, 0
    v_and_b32 v46, 31, v1
    v_lshlrev_b32 v47, 3, v46
    v_lshlrev_b32 v46, 4, v46
    v_lshrrev_b32 v44, 5, v1
    v_lshl_add_u32 v47, v44, 2, v47
    v_mov_b32 v48, s93
    s_lshl_b32 s45, s41, 9
    s_add_u32 s45, s45, s62
    s_lshl_b32 s46, s41, 3
    s_add_u32 s46, s46, s63
    s_lshl_b32 s47, s40, 10
    s_lshl_b32 s49, s42, 8
    s_add_u32 s47, s47, s49
    s_mov_b32 s50, 0
    s_cmp_lg_u32 s44, 0
    s_cbranch_scc1 L_notree2b
    v_cvt_pk_bf16_f32 v51, v36, v36
    v_and_b32 v28, v51, v16
    v_and_b32 v29, v51, v17
    v_and_b32 v30, v51, v18
    v_and_b32 v31, v51, v19
    s_nop 1
    v_mfma_f32_16x16x32_bf16 v[20:23], v[56:59], v[28:31], v[20:23]
    v_mfma_f32_16x16x32_bf16 v[24:27], v[60:63], v[28:31], v[24:27]
L_notree2b:
    v_cvt_pk_bf16_f32 v51, v128, v128
    v_and_b32 v32, v51, v16
    v_and_b32 v33, v51, v17
    v_and_b32 v34, v51, v18
    v_and_b32 v35, v51, v19
    s_nop 0
    s_waitcnt vmcnt(16)
    v_mfma_f32_16x16x32_bf16 v[20:23], a[0:3], v[32:35], v[20:23]
    s_waitcnt vmcnt(15)
    v_mfma_f32_16x16x32_bf16 v[24:27], a[4:7], v[32:35], v[24:27]
    v_cvt_pk_bf16_f32 v51, v129, v129
    v_and_b32 v28, v51, v16
    v_and_b32 v29, v51, v17
    v_and_b32 v30, v51, v18
    v_and_b32 v31, v51, v19
    s_nop 0
    s_waitcnt vmcnt(14)
    v_mfma_f32_16x16x32_bf16 v[20:23], a[8:11], v[28:31], v[20:23]
    s_waitcnt vmcnt(13)
    v_mfma_f32_16x16x32_bf16 v[24:27], a[12:15], v[28:31], v[24:27]
    v_cvt_pk_bf16_f32 v51, v130, v130
    v_and_b32 v32, v51, v16
    v_and_b32 v33, v51, v17
    v_and_b32 v34, v51, v18
    v_and_b32 v35, v51, v19
    s_nop 0
    s_waitcnt vmcnt(12)
    v_mfma_f32_16x16x32_bf16 v[20:23], a[16:19], v[32:35], v[20:23]
    s_waitcnt vmcnt(11)
    v_mfma_f32_16x16x32_bf16 v[24:27], a[20:23], v[32:35], v[24:27]
    v_cvt_pk_bf16_f32 v51, v131, v131
    v_and_b32 v28, v51, v16
    v_and_b32 v29, v51, v17
    v_and_b32 v30, v51, v18
    v_and_b32 v31, v51, v19
    s_nop 0
    s_waitcnt vmcnt(10)
    v_mfma_f32_16x16x32_bf16 v[20:23], a[24:27], v[28:31], v[20:23]
    s_waitcnt vmcnt(9)
    v_mfma_f32_16x16x32_bf16 v[24:27], a[28:31], v[28:31], v[24:27]
    buffer_load_dwordx4 a[0:3], v14, s[12:15], s56 offen offset:0 nt
    buffer_load_dwordx4 a[4:7], v14, s[12:15], s56 offen offset:256 nt
    buffer_load_dwordx4 a[8:11], v14, s[12:15], s56 offen offset:2048 nt
    buffer_load_dwordx4 a[12:15], v14, s[12:15], s56 offen offset:2304 nt
    buffer_load_dwordx4 a[16:19], v15, s[12:15], s56 offen offset:0 nt
    buffer_load_dwordx4 a[20:23], v15, s[12:15], s56 offen offset:256 nt
    buffer_load_dwordx4 a[24:27], v15, s[12:15], s56 offen offset:2048 nt
    buffer_load_dwordx4 a[28:31], v15, s[12:15], s56 offen offset:2304 nt
    v_cvt_pk_bf16_f32 v51, v132, v132
    v_and_b32 v32, v51, v16
    v_and_b32 v33, v51, v17
    v_and_b32 v34, v51, v18
    v_and_b32 v35, v51, v19
    s_nop 0
    s_waitcnt vmcnt(16)
    v_mfma_f32_16x16x32_bf16 v[20:23], a[32:35], v[32:35], v[20:23]
    s_waitcnt vmcnt(15)
    v_mfma_f32_16x16x32_bf16 v[24:27], a[36:39], v[32:35], v[24:27]
    v_cvt_pk_bf16_f32 v51, v133, v133
    v_and_b32 v28, v51, v16
    v_and_b32 v29, v51, v17
    v_and_b32 v30, v51, v18
    v_and_b32 v31, v51, v19
    s_nop 0
    s_waitcnt vmcnt(14)
    v_mfma_f32_16x16x32_bf16 v[20:23], a[40:43], v[28:31], v[20:23]
    s_waitcnt vmcnt(13)
    v_mfma_f32_16x16x32_bf16 v[24:27], a[44:47], v[28:31], v[24:27]
    v_cvt_pk_bf16_f32 v51, v134, v134
    v_and_b32 v32, v51, v16
    v_and_b32 v33, v51, v17
    v_and_b32 v34, v51, v18
    v_and_b32 v35, v51, v19
    s_nop 0
    s_waitcnt vmcnt(12)
    v_mfma_f32_16x16x32_bf16 v[20:23], a[48:51], v[32:35], v[20:23]
    s_waitcnt vmcnt(11)
    v_mfma_f32_16x16x32_bf16 v[24:27], a[52:55], v[32:35], v[24:27]
    v_cvt_pk_bf16_f32 v51, v135, v135
    v_and_b32 v28, v51, v16
    v_and_b32 v29, v51, v17
    v_and_b32 v30, v51, v18
    v_and_b32 v31, v51, v19
    s_nop 0
    s_waitcnt vmcnt(10)
    v_mfma_f32_16x16x32_bf16 v[20:23], a[56:59], v[28:31], v[20:23]
    s_waitcnt vmcnt(9)
    v_mfma_f32_16x16x32_bf16 v[24:27], a[60:63], v[28:31], v[24:27]
    buffer_load_dwordx4 a[32:35], v14, s[12:15], s57 offen offset:0 nt
    buffer_load_dwordx4 a[36:39], v14, s[12:15], s57 offen offset:256 nt
    buffer_load_dwordx4 a[40:43], v14, s[12:15], s57 offen offset:2048 nt
    buffer_load_dwordx4 a[44:47], v14, s[12:15], s57 offen offset:2304 nt
    buffer_load_dwordx4 a[48:51], v15, s[12:15], s57 offen offset:0 nt
    buffer_load_dwordx4 a[52:55], v15, s[12:15], s57 offen offset:256 nt
    buffer_load_dwordx4 a[56:59], v15, s[12:15], s57 offen offset:2048 nt
    buffer_load_dwordx4 a[60:63], v15, s[12:15], s57 offen offset:2304 nt
    v_cvt_pk_bf16_f32 v51, v136, v136
    v_and_b32 v32, v51, v16
    v_and_b32 v33, v51, v17
    v_and_b32 v34, v51, v18
    v_and_b32 v35, v51, v19
    s_nop 0
    s_waitcnt vmcnt(15)
    v_mfma_f32_16x16x32_bf16 v[20:23], a[0:3], v[32:35], v[20:23]
    s_waitcnt vmcnt(14)
    v_mfma_f32_16x16x32_bf16 v[24:27], a[4:7], v[32:35], v[24:27]
    v_cvt_pk_bf16_f32 v51, v137, v137
    v_and_b32 v28, v51, v16
    v_and_b32 v29, v51, v17
    v_and_b32 v30, v51, v18
    v_and_b32 v31, v51, v19
    s_nop 0
    s_waitcnt vmcnt(13)
    v_mfma_f32_16x16x32_bf16 v[20:23], a[8:11], v[28:31], v[20:23]
    s_waitcnt vmcnt(12)
    v_mfma_f32_16x16x32_bf16 v[24:27], a[12:15], v[28:31], v[24:27]
    v_cvt_pk_bf16_f32 v51, v138, v138
    v_and_b32 v32, v51, v16
    v_and_b32 v33, v51, v17
    v_and_b32 v34, v51, v18
    v_and_b32 v35, v51, v19
    s_nop 0
    s_waitcnt vmcnt(11)
    v_mfma_f32_16x16x32_bf16 v[20:23], a[16:19], v[32:35], v[20:23]
    s_waitcnt vmcnt(10)
    v_mfma_f32_16x16x32_bf16 v[24:27], a[20:23], v[32:35], v[24:27]
    v_cvt_pk_bf16_f32 v51, v139, v139
    v_and_b32 v28, v51, v16
    v_and_b32 v29, v51, v17
    v_and_b32 v30, v51, v18
    v_and_b32 v31, v51, v19
    s_nop 0
    s_waitcnt vmcnt(9)
    v_mfma_f32_16x16x32_bf16 v[20:23], a[24:27], v[28:31], v[20:23]
    s_waitcnt vmcnt(8)
    v_mfma_f32_16x16x32_bf16 v[24:27], a[28:31], v[28:31], v[24:27]
    buffer_load_dwordx4 a[0:3], v14, s[12:15], s58 offen offset:0 nt
    buffer_load_dwordx4 a[4:7], v14, s[12:15], s58 offen offset:256 nt
    buffer_load_dwordx4 a[8:11], v14, s[12:15], s58 offen offset:2048 nt
    buffer_load_dwordx4 a[12:15], v14, s[12:15], s58 offen offset:2304 nt
    buffer_load_dwordx4 a[16:19], v15, s[12:15], s58 offen offset:0 nt
    buffer_load_dwordx4 a[20:23], v15, s[12:15], s58 offen offset:256 nt
    buffer_load_dwordx4 a[24:27], v15, s[12:15], s58 offen offset:2048 nt
    buffer_load_dwordx4 a[28:31], v15, s[12:15], s58 offen offset:2304 nt
    v_cvt_pk_bf16_f32 v51, v140, v140
    v_and_b32 v32, v51, v16
    v_and_b32 v33, v51, v17
    v_and_b32 v34, v51, v18
    v_and_b32 v35, v51, v19
    s_nop 0
    s_waitcnt vmcnt(15)
    v_mfma_f32_16x16x32_bf16 v[20:23], a[32:35], v[32:35], v[20:23]
    s_waitcnt vmcnt(14)
    v_mfma_f32_16x16x32_bf16 v[24:27], a[36:39], v[32:35], v[24:27]
    v_cvt_pk_bf16_f32 v51, v141, v141
    v_and_b32 v28, v51, v16
    v_and_b32 v29, v51, v17
    v_and_b32 v30, v51, v18
    v_and_b32 v31, v51, v19
    s_nop 0
    s_waitcnt vmcnt(13)
    v_mfma_f32_16x16x32_bf16 v[20:23], a[40:43], v[28:31], v[20:23]
    s_waitcnt vmcnt(12)
    v_mfma_f32_16x16x32_bf16 v[24:27], a[44:47], v[28:31], v[24:27]
    v_cvt_pk_bf16_f32 v51, v142, v142
    v_and_b32 v32, v51, v16
    v_and_b32 v33, v51, v17
    v_and_b32 v34, v51, v18
    v_and_b32 v35, v51, v19
    s_nop 0
    s_waitcnt vmcnt(11)
    v_mfma_f32_16x16x32_bf16 v[20:23], a[48:51], v[32:35], v[20:23]
    s_waitcnt vmcnt(10)
    v_mfma_f32_16x16x32_bf16 v[24:27], a[52:55], v[32:35], v[24:27]
    v_cvt_pk_bf16_f32 v51, v143, v143
    v_and_b32 v28, v51, v16
    v_and_b32 v29, v51, v17
    v_and_b32 v30, v51, v18
    v_and_b32 v31, v51, v19
    s_nop 0
    s_waitcnt vmcnt(9)
    v_mfma_f32_16x16x32_bf16 v[20:23], a[56:59], v[28:31], v[20:23]
    s_waitcnt vmcnt(8)
    v_mfma_f32_16x16x32_bf16 v[24:27], a[60:63], v[28:31], v[24:27]
    buffer_load_dwordx4 a[32:35], v14, s[12:15], s59 offen offset:0 nt
    buffer_load_dwordx4 a[36:39], v14, s[12:15], s59 offen offset:256 nt
    buffer_load_dwordx4 a[40:43], v14, s[12:15], s59 offen offset:2048 nt
    buffer_load_dwordx4 a[44:47], v14, s[12:15], s59 offen offset:2304 nt
    buffer_load_dwordx4 a[48:51], v15, s[12:15], s59 offen offset:0 nt
    buffer_load_dwordx4 a[52:55], v15, s[12:15], s59 offen offset:256 nt
    buffer_load_dwordx4 a[56:59], v15, s[12:15], s59 offen offset:2048 nt
    buffer_load_dwordx4 a[60:63], v15, s[12:15], s59 offen offset:2304 nt
    v_cvt_pk_bf16_f32 v51, v144, v144
    v_and_b32 v32, v51, v16
    v_and_b32 v33, v51, v17
    v_and_b32 v34, v51, v18
    v_and_b32 v35, v51, v19
    s_nop 0
    s_waitcnt vmcnt(15)
    v_mfma_f32_16x16x32_bf16 v[20:23], a[0:3], v[32:35], v[20:23]
    s_waitcnt vmcnt(14)
    v_mfma_f32_16x16x32_bf16 v[24:27], a[4:7], v[32:35], v[24:27]
    v_cvt_pk_bf16_f32 v51, v145, v145
    v_and_b32 v28, v51, v16
    v_and_b32 v29, v51, v17
    v_and_b32 v30, v51, v18
    v_and_b32 v31, v51, v19
    s_nop 0
    s_waitcnt vmcnt(13)
    v_mfma_f32_16x16x32_bf16 v[20:23], a[8:11], v[28:31], v[20:23]
    s_waitcnt vmcnt(12)
    v_mfma_f32_16x16x32_bf16 v[24:27], a[12:15], v[28:31], v[24:27]
    v_cvt_pk_bf16_f32 v51, v146, v146
    v_and_b32 v32, v51, v16
    v_and_b32 v33, v51, v17
    v_and_b32 v34, v51, v18
    v_and_b32 v35, v51, v19
    s_nop 0
    s_waitcnt vmcnt(11)
    v_mfma_f32_16x16x32_bf16 v[20:23], a[16:19], v[32:35], v[20:23]
    s_waitcnt vmcnt(10)
    v_mfma_f32_16x16x32_bf16 v[24:27], a[20:23], v[32:35], v[24:27]
    v_cvt_pk_bf16_f32 v51, v147, v147
    v_and_b32 v28, v51, v16
    v_and_b32 v29, v51, v17
    v_and_b32 v30, v51, v18
    v_and_b32 v31, v51, v19
    s_nop 0
    s_waitcnt vmcnt(9)
    v_mfma_f32_16x16x32_bf16 v[20:23], a[24:27], v[28:31], v[20:23]
    s_waitcnt vmcnt(8)
    v_mfma_f32_16x16x32_bf16 v[24:27], a[28:31], v[28:31], v[24:27]
    buffer_load_dwordx4 a[0:3], v14, s[12:15], s60 offen offset:0 nt
    buffer_load_dwordx4 a[4:7], v14, s[12:15], s60 offen offset:256 nt
    buffer_load_dwordx4 a[8:11], v14, s[12:15], s60 offen offset:2048 nt
    buffer_load_dwordx4 a[12:15], v14, s[12:15], s60 offen offset:2304 nt
    buffer_load_dwordx4 a[16:19], v15, s[12:15], s60 offen offset:0 nt
    buffer_load_dwordx4 a[20:23], v15, s[12:15], s60 offen offset:256 nt
    buffer_load_dwordx4 a[24:27], v15, s[12:15], s60 offen offset:2048 nt
    buffer_load_dwordx4 a[28:31], v15, s[12:15], s60 offen offset:2304 nt
    v_cvt_pk_bf16_f32 v51, v148, v148
    v_and_b32 v32, v51, v16
    v_and_b32 v33, v51, v17
    v_and_b32 v34, v51, v18
    v_and_b32 v35, v51, v19
    s_nop 0
    s_waitcnt vmcnt(15)
    v_mfma_f32_16x16x32_bf16 v[20:23], a[32:35], v[32:35], v[20:23]
    s_waitcnt vmcnt(14)
    v_mfma_f32_16x16x32_bf16 v[24:27], a[36:39], v[32:35], v[24:27]
    v_cvt_pk_bf16_f32 v51, v149, v149
    v_and_b32 v28, v51, v16
    v_and_b32 v29, v51, v17
    v_and_b32 v30, v51, v18
    v_and_b32 v31, v51, v19
    s_nop 0
    s_waitcnt vmcnt(13)
    v_mfma_f32_16x16x32_bf16 v[20:23], a[40:43], v[28:31], v[20:23]
    s_waitcnt vmcnt(12)
    v_mfma_f32_16x16x32_bf16 v[24:27], a[44:47], v[28:31], v[24:27]
    v_cvt_pk_bf16_f32 v51, v150, v150
    v_and_b32 v32, v51, v16
    v_and_b32 v33, v51, v17
    v_and_b32 v34, v51, v18
    v_and_b32 v35, v51, v19
    s_nop 0
    s_waitcnt vmcnt(11)
    v_mfma_f32_16x16x32_bf16 v[20:23], a[48:51], v[32:35], v[20:23]
    s_waitcnt vmcnt(10)
    v_mfma_f32_16x16x32_bf16 v[24:27], a[52:55], v[32:35], v[24:27]
    v_cvt_pk_bf16_f32 v51, v151, v151
    v_and_b32 v28, v51, v16
    v_and_b32 v29, v51, v17
    v_and_b32 v30, v51, v18
    v_and_b32 v31, v51, v19
    s_nop 0
    s_waitcnt vmcnt(9)
    v_mfma_f32_16x16x32_bf16 v[20:23], a[56:59], v[28:31], v[20:23]
    s_waitcnt vmcnt(8)
    v_mfma_f32_16x16x32_bf16 v[24:27], a[60:63], v[28:31], v[24:27]
    buffer_load_dwordx4 a[32:35], v14, s[12:15], s61 offen offset:0 nt
    buffer_load_dwordx4 a[36:39], v14, s[12:15], s61 offen offset:256 nt
    buffer_load_dwordx4 a[40:43], v14, s[12:15], s61 offen offset:2048 nt
    buffer_load_dwordx4 a[44:47], v14, s[12:15], s61 offen offset:2304 nt
    buffer_load_dwordx4 a[48:51], v15, s[12:15], s61 offen offset:0 nt
    buffer_load_dwordx4 a[52:55], v15, s[12:15], s61 offen offset:256 nt
    buffer_load_dwordx4 a[56:59], v15, s[12:15], s61 offen offset:2048 nt
    buffer_load_dwordx4 a[60:63], v15, s[12:15], s61 offen offset:2304 nt
    v_cvt_pk_bf16_f32 v51, v152, v152
    v_and_b32 v32, v51, v16
    v_and_b32 v33, v51, v17
    v_and_b32 v34, v51, v18
    v_and_b32 v35, v51, v19
    s_nop 0
    s_waitcnt vmcnt(15)
    v_mfma_f32_16x16x32_bf16 v[20:23], a[0:3], v[32:35], v[20:23]
    s_waitcnt vmcnt(14)
    v_mfma_f32_16x16x32_bf16 v[24:27], a[4:7], v[32:35], v[24:27]
    v_cvt_pk_bf16_f32 v51, v153, v153
    v_and_b32 v28, v51, v16
    v_and_b32 v29, v51, v17
    v_and_b32 v30, v51, v18
    v_and_b32 v31, v51, v19
    s_nop 0
    s_waitcnt vmcnt(13)
    v_mfma_f32_16x16x32_bf16 v[20:23], a[8:11], v[28:31], v[20:23]
    s_waitcnt vmcnt(12)
    v_mfma_f32_16x16x32_bf16 v[24:27], a[12:15], v[28:31], v[24:27]
    s_add_u32 s48, s45, 2097152
    s_add_u32 s49, s46, 2097152
    s_mov_b32 exec_hi, 0
    buffer_load_dwordx4 v[56:59], v46, s[16:19], s48 offen sc1
    s_mov_b64 exec, 1
    buffer_load_dwordx2 v[60:61], v45, s[16:19], s49 offen sc1
    s_mov_b64 exec, -1
    v_cvt_pk_bf16_f32 v51, v154, v154
    v_and_b32 v32, v51, v16
    v_and_b32 v33, v51, v17
    v_and_b32 v34, v51, v18
    v_and_b32 v35, v51, v19
    s_nop 0
    s_waitcnt vmcnt(13)
    v_mfma_f32_16x16x32_bf16 v[20:23], a[16:19], v[32:35], v[20:23]
    s_waitcnt vmcnt(12)
    v_mfma_f32_16x16x32_bf16 v[24:27], a[20:23], v[32:35], v[24:27]
    v_cvt_pk_bf16_f32 v51, v155, v155
    v_and_b32 v28, v51, v16
    v_and_b32 v29, v51, v17
    v_and_b32 v30, v51, v18
    v_and_b32 v31, v51, v19
    s_nop 0
    s_waitcnt vmcnt(11)
    v_mfma_f32_16x16x32_bf16 v[20:23], a[24:27], v[28:31], v[20:23]
    s_waitcnt vmcnt(10)
    v_mfma_f32_16x16x32_bf16 v[24:27], a[28:31], v[28:31], v[24:27]
    v_mov_b32 v53, 0x2000000
    s_mov_b64 exec, 1
    buffer_atomic_add v53, v54, s[24:27], 0 offen sc0
    s_mov_b64 exec, -1
    v_cvt_pk_bf16_f32 v51, v156, v156
    v_and_b32 v32, v51, v16
    v_and_b32 v33, v51, v17
    v_and_b32 v34, v51, v18
    v_and_b32 v35, v51, v19
    s_nop 0
    s_waitcnt vmcnt(10)
    v_mfma_f32_16x16x32_bf16 v[20:23], a[32:35], v[32:35], v[20:23]
    s_waitcnt vmcnt(9)
    v_mfma_f32_16x16x32_bf16 v[24:27], a[36:39], v[32:35], v[24:27]
    v_cvt_pk_bf16_f32 v51, v157, v157
    v_and_b32 v28, v51, v16
    v_and_b32 v29, v51, v17
    v_and_b32 v30, v51, v18
    v_and_b32 v31, v51, v19
    s_nop 0
    s_waitcnt vmcnt(8)
    v_mfma_f32_16x16x32_bf16 v[20:23], a[40:43], v[28:31], v[20:23]
    s_waitcnt vmcnt(7)
    v_mfma_f32_16x16x32_bf16 v[24:27], a[44:47], v[28:31], v[24:27]
    v_cvt_pk_bf16_f32 v51, v158, v158
    v_and_b32 v32, v51, v16
    v_and_b32 v33, v51, v17
    v_and_b32 v34, v51, v18
    v_and_b32 v35, v51, v19
    s_nop 0
    s_waitcnt vmcnt(6)
    v_mfma_f32_16x16x32_bf16 v[20:23], a[48:51], v[32:35], v[20:23]
    s_waitcnt vmcnt(5)
    v_mfma_f32_16x16x32_bf16 v[24:27], a[52:55], v[32:35], v[24:27]
    v_cvt_pk_bf16_f32 v51, v159, v159
    v_and_b32 v28, v51, v16
    v_and_b32 v29, v51, v17
    v_and_b32 v30, v51, v18
    v_and_b32 v31, v51, v19
    s_nop 0
    s_waitcnt vmcnt(4)
    v_mfma_f32_16x16x32_bf16 v[20:23], a[56:59], v[28:31], v[20:23]
    s_waitcnt vmcnt(3)
    v_mfma_f32_16x16x32_bf16 v[24:27], a[60:63], v[28:31], v[24:27]
L_join:
    s_waitcnt vmcnt(0)
    s_cmp_lg_u32 s42, 0
    s_cbranch_scc1 L_noflag
    s_mov_b64 exec, 1
    ds_write_b32 v45, v53 offset:8256
    s_mov_b64 exec, -1
L_noflag:
    s_nop 5
    ds_write_b32 v41, v20 offset:0
    ds_write_b32 v41, v21 offset:256
    ds_write_b32 v41, v22 offset:512
    ds_write_b32 v41, v23 offset:768
    ds_write_b32 v41, v24 offset:1024
    ds_write_b32 v41, v25 offset:1280
    ds_write_b32 v41, v26 offset:1536
    ds_write_b32 v41, v27 offset:1792
    s_waitcnt lgkmcnt(0)
    s_barrier
    ds_read_b32 v53, v45 offset:8256
    ds_read_b128 v[128:131], v43 offset:8224
    ds_read_b128 v[132:135], v42 offset:0
    ds_read_b128 v[136:139], v42 offset:2048
    ds_read_b128 v[140:143], v42 offset:4096
    ds_read_b128 v[144:147], v42 offset:6144
    s_waitcnt lgkmcnt(4)
    v_add_f32 v49, v128, v129
    v_add_f32 v50, v130, v131
    v_readfirstlane_b32 s52, v53
    s_waitcnt lgkmcnt(2)
    v_add_f32 v148, v132, v136
    v_add_f32 v149, v133, v137
    v_add_f32 v150, v134, v138
    v_add_f32 v151, v135, v139
    v_add_f32 v49, v49, v50
    s_waitcnt lgkmcnt(0)
    v_add_f32 v140, v140, v144
    v_add_f32 v141, v141, v145
    v_add_f32 v142, v142, v146
    v_add_f32 v143, v143, v147
    v_add_f32 v148, v148, v140
    v_add_f32 v149, v149, v141
    v_add_f32 v150, v150, v142
    v_add_f32 v151, v151, v143
    s_add_u32 s48, s45, 2097152
    s_add_u32 s49, s46, 2097152
    s_mov_b32 exec_hi, 0
    buffer_store_dwordx4 v[148:151], v46, s[16:19], s48 offen
    s_mov_b64 exec, 1
    buffer_store_dwordx2 v[48:49], v45, s[16:19], s49 offen
    s_and_b32 s48, s52, 0x1ffffff
    s_cmp_eq_u32 s48, s95
    s_cbranch_scc1 L_noB
    s_mov_b32 exec_lo, -1
    buffer_store_dwordx4 v[148:151], v46, s[16:19], s45 offen sc1
    s_mov_b32 exec_lo, 1
    buffer_store_dwordx2 v[48:49], v45, s[16:19], s46 offen sc1
L_noB:
    s_mov_b64 exec, -1
    s_lshr_b32 s48, s52, 25
    s_cmp_lt_u32 s48, 28
    s_cbranch_scc1 L_fin
    s_sub_u32 s48, s48, 28
    s_mov_b32 s50, 0
L_chk:
    s_and_b32 s49, s52, 63
    s_cmp_eq_u32 s49, 32
    s_cbranch_scc1 L_allclr
    s_add_u32 s50, s50, 1
    s_cmp_ge_u32 s50, 1048576
    s_cbranch_scc1 L_fin
    s_lshl_b32 s49, s40, 5
    v_mov_b32 v50, s49
    buffer_load_dword v51, v50, s[24:27], 0 offen sc1
    s_waitcnt vmcnt(0)
    v_readfirstlane_b32 s52, v51
    s_nop 3
    s_branch L_chk
L_allclr:
    s_and_b32 s49, s52, 0x1ffffff
    s_cmp_eq_u32 s49, s95
    s_cselect_b32 s93, 2097152, 0
    s_lshl_b32 s49, s40, 16
    s_lshl_b32 s51, s48, 14
    s_add_u32 s49, s49, s51
    s_add_u32 s49, s49, s93
    s_lshl_b32 s51, s40, 10
    s_add_u32 s51, s51, s93
    s_lshl_b32 s93, s48, 8
    s_add_u32 s51, s51, s93
    s_add_u32 s51, s51, 0x100000
    s_lshl_b32 s47, s40, 10
    s_add_u32 s47, s47, s93
    s_lshl_b32 s93, s42, 6
    s_add_u32 s47, s47, s93
    s_mov_b32 s50, 0
    s_branch L_round
L_retry:
    s_add_u32 s50, s50, 1
    s_cmp_ge_u32 s50, 1048576
    s_cbranch_scc1 L_store
L_round:
    buffer_load_dwordx4 v[64:67], v55, s[16:19], s51 offen sc1
    buffer_load_dwordx4 v[68:71], v55, s[16:19], s51 offen offset:16 sc1
    buffer_load_dwordx4 v[72:75], v160, s[16:19], s49 offen offset:0 sc1
    buffer_load_dwordx4 v[76:79], v160, s[16:19], s49 offen offset:512 sc1
    buffer_load_dwordx4 v[80:83], v160, s[16:19], s49 offen offset:1024 sc1
    buffer_load_dwordx4 v[84:87], v160, s[16:19], s49 offen offset:1536 sc1
    s_waitcnt vmcnt(4)
    v_max3_u32 v51, v64, v65, v66
    v_max3_u32 v51, v67, v68, v51
    v_max3_u32 v51, v69, v70, v51
    v_max_u32 v51, v71, v51
    v_max3_f32 v50, v64, v66, v68
    v_cmp_eq_u32 vcc, -1, v51
    v_max_f32 v50, v50, v70
    s_nop 3
    s_cbranch_vccnz L_retry
    v_max_f32_dpp v50, v50, v50 row_ror:8 row_mask:0xf bank_mask:0xf
    v_mov_b32 v51, v50
    s_nop 1
    v_permlane16_swap_b32 v50, v51
    v_max_f32 v50, v50, v51
    v_mov_b32 v51, v50
    s_nop 1
    v_permlane32_swap_b32 v50, v51
    v_max_f32 v50, v50, v51
    v_sub_f32 v88, v64, v50
    v_sub_f32 v89, v66, v50
    v_sub_f32 v90, v68, v50
    v_sub_f32 v91, v70, v50
    v_exp_f32 v88, v88
    v_exp_f32 v89, v89
    v_exp_f32 v90, v90
    v_exp_f32 v91, v91
    s_waitcnt vmcnt(0)
    v_mul_f32 v50, v88, v65
    v_mul_f32 v20, v88, v72
    v_mul_f32 v21, v88, v73
    v_mul_f32 v22, v88, v74
    v_mul_f32 v23, v88, v75
    v_fmac_f32 v50, v89, v67
    v_fmac_f32 v20, v89, v76
    v_fmac_f32 v21, v89, v77
    v_fmac_f32 v22, v89, v78
    v_fmac_f32 v23, v89, v79
    v_fmac_f32 v50, v90, v69
    v_fmac_f32 v20, v90, v80
    v_fmac_f32 v21, v90, v81
    v_fmac_f32 v22, v90, v82
    v_fmac_f32 v23, v90, v83
    v_fmac_f32 v50, v91, v71
    v_fmac_f32 v20, v91, v84
    v_fmac_f32 v21, v91, v85
    v_fmac_f32 v22, v91, v86
    v_fmac_f32 v23, v91, v87
    s_nop 0
    v_add_f32_dpp v50, v50, v50 row_ror:8 row_mask:0xf bank_mask:0xf
    v_add_f32_dpp v20, v20, v20 row_ror:8 row_mask:0xf bank_mask:0xf
    v_add_f32_dpp v21, v21, v21 row_ror:8 row_mask:0xf bank_mask:0xf
    v_add_f32_dpp v22, v22, v22 row_ror:8 row_mask:0xf bank_mask:0xf
    v_add_f32_dpp v23, v23, v23 row_ror:8 row_mask:0xf bank_mask:0xf
    v_mov_b32 v51, v50
    s_nop 0
    v_permlane16_swap_b32 v20, v21
    v_permlane16_swap_b32 v50, v51
    v_permlane16_swap_b32 v22, v23
    v_add_f32 v20, v20, v21
    v_add_f32 v50, v50, v51
    v_add_f32 v22, v22, v23
    v_mov_b32 v51, v50
    s_nop 1
    v_permlane32_swap_b32 v50, v51
    v_permlane32_swap_b32 v20, v22
    v_add_f32 v50, v50, v51
    v_add_f32 v20, v20, v22
    v_rcp_f32 v50, v50
    s_nop 0
    v_mul_f32 v20, v20, v50
    v_cmp_u_f32 vcc, v20, v20
    v_cvt_pk_bf16_f32 v24, v20, v20
    s_nop 3
    s_cbranch_vccz L_store
    v_max_u32 v51, v72, v73
    v_max3_u32 v51, v74, v75, v51
    v_max3_u32 v51, v76, v77, v51
    v_max3_u32 v51, v78, v79, v51
    v_max3_u32 v51, v80, v81, v51
    v_max3_u32 v51, v82, v83, v51
    v_max3_u32 v51, v84, v85, v51
    v_max3_u32 v51, v86, v87, v51
    v_cmp_eq_u32 vcc, -1, v51
    s_nop 4
    s_cbranch_vccnz L_retry
L_store:
    s_mov_b32 exec_lo, 0x00ff00ff
    s_mov_b32 exec_hi, 0x00ff00ff
    buffer_store_short v24, v161, s[20:23], s47 offen
    s_mov_b64 exec, -1
L_fin:
L_end:
    s_endpgm

.section .rodata,"a"
.p2align 6
.amdhsa_kernel standalone__tree_speculative_verify_tree_attention_over_candidate_token_tree__decode_kernel
  .amdhsa_next_free_vgpr 240
  .amdhsa_next_free_sgpr 96
  .amdhsa_accum_offset 176
  .amdhsa_group_segment_fixed_size 0
  .amdhsa_kernarg_size 72
  .amdhsa_user_sgpr_count 2
  .amdhsa_user_sgpr_kernarg_segment_ptr 1
  .amdhsa_system_sgpr_workgroup_id_x 1
  .amdhsa_float_denorm_mode_32 3
.end_amdhsa_kernel
```
